```python
import torch

def _softmax(x, axis=-1):
    return torch.softmax(x, dim=axis)
def _gelu(x):
    return torch.nn.functional.gelu(x, approximate="tanh")
def _silu(x):
    return torch.nn.functional.silu(x)
def _sigmoid(x):
    return torch.sigmoid(x)
def _layernorm(x, axis=-1, eps=1e-5):
    m = x.mean(dim=axis, keepdim=True)
    v = x.var(dim=axis, keepdim=True, unbiased=False)
    return (x - m) / torch.sqrt(v + eps)
def _scatter_add(tgt, idx, src, axis=0):
    return tgt.clone().index_add_(axis, idx, src)
def _segment_sum(src, seg, n):
    out = torch.zeros((n,) + src.shape[1:], dtype=src.dtype)
    return out.index_add_(0, seg, src)
def _pad(x, pw):
    flat = tuple(v for pair in reversed(pw) for v in pair)
    return torch.nn.functional.pad(x, flat)

kernel_name = 'concat_heads__ssm_conv_s4d__ssm_conv_h3__prompt'

def setup_inputs():

    _w = (lambda a: (lambda t: t.to(torch.bfloat16) if t.is_floating_point() else t)(torch.as_tensor(a)))
    def _A_setup():
        Bsz, L, D, N = 1, 2048, 640, 192
        return {
            "u": _w((lambda *s: torch.randn(*s, dtype=torch.bfloat16) * 0.05)(Bsz, L, D)),
            "log_A_real": _w((lambda *s: torch.randn(*s, dtype=torch.bfloat16) * 3.2)(D, N) * 0.5),
            "A_imag": _w((lambda *s: torch.randn(*s, dtype=torch.bfloat16) * 0.05)(D, N) * 3.14),
            "C_real": _w((lambda *s: torch.randn(*s, dtype=torch.bfloat16) * 0.1)(D, N) / N ** 0.5),
            "C_imag": _w((lambda *s: torch.randn(*s, dtype=torch.bfloat16) * 0.1)(D, N) / N ** 0.5),
            "log_dt": _w((lambda *s: torch.randn(*s, dtype=torch.bfloat16) * 0.05)(D) * 0.5 - 4.0),
            "D_skip": _w((lambda *s: torch.randn(*s, dtype=torch.bfloat16) * 0.05)(D)),
        }
    _A_in = _A_setup()

    def _B_setup():
        B, S, D = 1, 2048, 640
        ks = 4
        return {
            "q": _w((lambda *s: torch.randn(*s, dtype=torch.bfloat16) * 0.05)(B, S, D)),
            "k": _w((lambda *s: torch.randn(*s, dtype=torch.bfloat16) * 0.2)(B, S, D)),
            "v": _w((lambda *s: torch.randn(*s, dtype=torch.bfloat16) * 0.2)(B, S, D)),
            "shift_k": _w((lambda *s: torch.randn(*s, dtype=torch.bfloat16) * 0.2)(D, ks) * 0.5),
            "ssm_k": _w((lambda *s: torch.randn(*s, dtype=torch.bfloat16) * 0.8)(D, S) * (1.0 / S ** 0.5)),
            "ssm_D": _w((lambda *s: torch.randn(*s, dtype=torch.bfloat16) * 0.2)(D)),
        }
    _B_in = _B_setup()

    return {
        "A_u": _A_in["u"],
        "A_log_A_real": _A_in["log_A_real"],
        "A_A_imag": _A_in["A_imag"],
        "A_C_real": _A_in["C_real"],
        "A_C_imag": _A_in["C_imag"],
        "A_log_dt": _A_in["log_dt"],
        "A_D_skip": _A_in["D_skip"],
        "B_q": _B_in["q"],
        "B_k": _B_in["k"],
        "B_v": _B_in["v"],
        "B_shift_k": _B_in["shift_k"],
        "B_ssm_k": _B_in["ssm_k"],
        "B_ssm_D": _B_in["ssm_D"],
    }

def reference(A_u, A_log_A_real, A_A_imag, A_C_real, A_C_imag, A_log_dt, A_D_skip, B_q, B_k, B_v, B_shift_k, B_ssm_k, B_ssm_D):
    def _A_ref(u, log_A_real, A_imag, C_real, C_imag, log_dt, D_skip):
        L = u.shape[1]
        dt = torch.exp(log_dt)
        A = -torch.exp(log_A_real) + 1j * A_imag
        C = (C_real + 1j * C_imag) * dt[:, None]
        pos = (lambda x, dt: x.to(dt))(torch.arange(L), log_dt.dtype)
        P = torch.exp((A * dt[:, None])[:, :, None] * pos[None, None, :])
        K = 2.0 * torch.einsum("dn,dnl->dl", C, P).real
        L2 = 2 * L
        u_t = (lambda x, *d: x.permute(*d))(u, 0, 2, 1)
        Kf = (lambda x, *a, **k: torch.fft.rfft(x.float(), *a, **k))(K, L2)
        Uf = (lambda x, *a, **k: torch.fft.rfft(x.float(), *a, **k))(u_t, L2)
        y = (lambda x, *a, **k: torch.fft.irfft(x, *a, **k).to(torch.bfloat16))(Uf * Kf[None, :, :], L2)[:, :, :L]
        y = (lambda x, *d: x.permute(*d))(y, 0, 2, 1)
        return y + u * D_skip[None, None, :]

    def _B_ref(q, k, v, shift_k, ssm_k, ssm_D):
        B, S, D = q.shape
        ks = shift_k.shape[-1]
        k_pad = _pad(k, ((0, 0), (ks - 1, 0), (0, 0)))
        k_shift = torch.zeros_like(k)
        for t in range(ks):
            k_shift = k_shift + k_pad[:, t:t + S, :] * shift_k[:, ks - 1 - t][None, None, :]
        kv = k_shift * v
        L = 2 * S
        kv_pad = _pad(kv, ((0, 0), (0, S), (0, 0)))
        kf_pad = _pad(ssm_k, ((0, 0), (0, S)))
        kv_f = (lambda x, axes=(-2,-1): torch.fft.rfft2(x.float(), dim=axes))(kv_pad[:, None, :, :], axes=(1, 2))
        kf_f = (lambda x, axes=(-2,-1): torch.fft.rfft2(x.float(), dim=axes))(kf_pad[:, None, :], axes=(1, 2))
        kf_f = (lambda x, *d: x.permute(*d))(kf_f, 1, 2, 0)
        y_f = kv_f * kf_f[None, :, :, :]
        y = (lambda x, s, axes=(-2,-1): torch.fft.irfft2(x, s=s, dim=axes).to(torch.bfloat16))(y_f, (1, L), axes=(1, 2))[:, 0, :S, :]
        y = y + kv * ssm_D[None, None, :]
        return q * y

    a = _A_ref(A_u, A_log_A_real, A_A_imag, A_C_real, A_C_imag, A_log_dt, A_D_skip)
    b = _B_ref(B_q, B_k, B_v, B_shift_k, B_ssm_k, B_ssm_D)
    return torch.concatenate([a, b], axis=-1)
```

```asm
; @launch kernel=prep_kernel grid=(256,1,1) block=(896,1,1) lds=141376
; @launch kernel=conv_kernel grid=(240,1,1) block=(512,1,1) lds=145920
.amdgcn_target "amdgcn-amd-amdhsa--gfx950"
.text
.globl prep_kernel
.p2align 8
.type prep_kernel,@function
prep_kernel:
    s_cmp_ge_u32 s2, 256
    s_cbranch_scc1 L_prep_exit
    s_load_dwordx16 s[16:31], s[0:1], 0
    s_load_dwordx16 s[32:47], s[0:1], 64
    s_getpc_b64 s[10:11]
L_pc_1:
    v_lshlrev_b32 v120, 7, v0
    v_min_u32 v120, L_prep_exit-L_pc_1-4, v120
    global_load_dword v121, v120, s[10:11]
    v_lshrrev_b32 v1, 6, v0
    v_and_b32 v2, 63, v0
    s_nop 0
    v_readfirstlane_b32 s3, v1
    s_mov_b32 s4, 0x9b436210
    s_mov_b32 s5, 0xa7cd85
    s_lshl_b32 s3, s3, 2
    s_lshr_b64 s[4:5], s[4:5], s3
    s_and_b32 s3, s4, 15
    s_cmp_lt_u32 s3, 5
    s_cbranch_scc1 L_tile
    s_setprio 3
    s_sub_u32 s6, s3, 5
    s_mul_i32 s7, s6, 43
    s_lshr_b32 s7, s7, 7
    s_mov_b32 s67, s7
    s_mul_i32 s4, s7, 3
    s_sub_u32 s4, s6, s4
    s_lshr_b32 s5, s2, 1
    s_mul_i32 s5, s5, 5
    s_and_b32 s8, s2, 1
    s_mul_i32 s9, s8, 3
    s_add_u32 s5, s5, s9
    s_add_u32 s5, s5, s7
    s_lshr_b32 s9, s7, 1
    s_and_b32 s9, s9, s8
    s_cmp_eq_u32 s9, 1
    s_cbranch_scc1 L_prep_exit
    s_mul_i32 s9, s5, 384
    s_lshl_b32 s7, s4, 7
    s_add_u32 s9, s9, s7
    v_lshl_add_u32 v3, v2, 1, s9
    v_mov_b32 v10, 0
    v_mov_b32 v11, 0
    v_mov_b32 v12, 0
    v_mov_b32 v13, 0
    s_lshl_b32 s7, s5, 1
    s_and_b32 s7, s7, 0xfffffffc
    s_mov_b32 s50, 245760
    s_mov_b32 s51, 0x00020000
    s_mov_b32 s54, 245760
    s_mov_b32 s55, 0x00020000
    s_mov_b32 s58, 245760
    s_mov_b32 s59, 0x00020000
    s_mov_b32 s62, 245760
    s_mov_b32 s63, 0x00020000
    v_lshlrev_b32 v4, 2, v2
    v_add_u32 v4, 141312, v4
    v_mov_b32 v5, 0
    s_mov_b64 exec, 31
    ds_write_b32 v4, v5
    s_mov_b64 exec, -1
    s_waitcnt lgkmcnt(0)
    s_mov_b32 s48, s18
    s_and_b32 s49, s19, 0xffff
    buffer_load_short_d16_hi v10, v3, s[48:51], 0 offen
    s_mov_b32 s52, s20
    s_and_b32 s53, s21, 0xffff
    buffer_load_short_d16_hi v11, v3, s[52:55], 0 offen
    s_mov_b32 s56, s22
    s_and_b32 s57, s23, 0xffff
    buffer_load_short_d16_hi v12, v3, s[56:59], 0 offen
    s_mov_b32 s60, s24
    s_and_b32 s61, s25, 0xffff
    buffer_load_short_d16_hi v13, v3, s[60:63], 0 offen
    s_barrier
    s_load_dword s64, s[26:27], s7
    s_load_dword s65, s[28:29], s7
    s_branch L_kgen
L_tile:
    s_lshr_b32 s8, s2, 2
    s_and_b32 s7, s2, 3
    s_mul_i32 s9, s8, 40960
    s_mul_i32 s10, s7, 320
    s_add_u32 s9, s9, s10
    s_lshl_b32 s11, s3, 6
    s_add_u32 s10, s10, s11
    s_lshl_b32 s12, s3, 6
    v_add_u32 v3, s12, v2
    v_mul_u32_u24 v4, 52429, v3
    v_lshrrev_b32 v4, 20, v4
    v_mul_u32_u24 v5, 20, v4
    v_sub_u32 v5, v3, v5
    v_mul_u32_u24 v6, 1280, v4
    v_lshl_add_u32 v6, v5, 4, v6
    v_add_u32 v5, s9, v6
    v_add_u32 v6, 20480, v5
    v_subrev_u32 v7, 5120, v5
    s_lshl_b32 s12, s3, 10
    s_waitcnt lgkmcnt(0)
    s_mov_b32 s48, s16
    s_and_b32 s49, s17, 0xffff
    s_mov_b32 s50, 2621440
    s_mov_b32 s51, 0x00020000
    s_mov_b32 s52, s32
    s_and_b32 s53, s33, 0xffff
    s_mov_b32 s54, 2621440
    s_mov_b32 s55, 0x00020000
    s_mov_b32 s56, s34
    s_and_b32 s57, s35, 0xffff
    s_mov_b32 s58, 2621440
    s_mov_b32 s59, 0x00020000
    s_mov_b32 s60, s36
    s_and_b32 s61, s37, 0xffff
    s_mov_b32 s62, 5120
    s_mov_b32 s63, 0x00020000
    v_bfe_u32 v8, v2, 4, 1
    v_and_b32 v10, 15, v2
    v_lshl_add_u32 v11, v8, 4, v10
    s_lshl_b32 s13, s10, 2
    v_lshl_add_u32 v12, v11, 3, s13
    s_barrier
    buffer_load_dwordx2 v[40:41], v12, s[60:63], 0 offen
    s_add_u32 m0, s12, 1280
    s_nop 0
    buffer_load_dwordx4 v5, s[52:55], 0 offen lds
    s_add_u32 m0, s12, 6400
    s_nop 0
    buffer_load_dwordx4 v6, s[52:55], 0 offen lds
    s_cmp_gt_u32 s3, 1
    s_cbranch_scc1 L_nohalo_2
    s_cmp_eq_u32 s3, 0
    s_cselect_b32 exec_hi, -1, 0
    s_cselect_b32 exec_lo, -1, 0xffff
    s_add_u32 m0, s12, 0
    s_nop 0
    buffer_load_dwordx4 v7, s[52:55], 0 offen lds
    s_mov_b64 exec, -1
L_nohalo_2:
    s_add_u32 m0, s12, 12288
    s_nop 0
    buffer_load_dwordx4 v5, s[56:59], 0 offen lds
    s_add_u32 m0, s12, 17408
    s_nop 0
    buffer_load_dwordx4 v6, s[56:59], 0 offen lds
    s_add_u32 m0, s12, 22528
    s_nop 0
    buffer_load_dwordx4 v5, s[48:51], 0 offen lds
    s_add_u32 m0, s12, 27648
    s_nop 0
    buffer_load_dwordx4 v6, s[48:51], 0 offen lds
    v_lshrrev_b32 v3, 2, v2
    v_and_b32 v4, 3, v2
    v_bfe_u32 v8, v2, 4, 1
    v_lshrrev_b32 v9, 5, v2
    v_and_b32 v10, 15, v2
    v_lshl_add_u32 v11, v8, 4, v10
    s_mov_b32 s64, s46
    s_and_b32 s65, s47, 0xffff
    s_mov_b32 s66, 10485760
    s_mov_b32 s67, 0x00020000
    v_and_b32 v13, 3, v3
    v_sub_u32 v13, 3, v13
    v_lshl_add_u32 v13, v9, 2, v13
    v_mul_u32_u24 v13, 320, v13
    v_lshl_add_u32 v13, v8, 5, v13
    v_lshl_add_u32 v13, v4, 3, v13
    v_add_u32 v13, s11, v13
    s_mul_i32 s12, s3, 5120
    s_add_u32 s12, s12, 32768
    v_mul_u32_u24 v14, 80, v11
    v_lshlrev_b32 v15, 3, v9
    v_sub_u32 v14, v14, v15
    s_add_u32 s13, s12, 8
    v_add_u32 v14, s13, v14
    v_mul_u32_u24 v15, 80, v3
    v_lshl_add_u32 v15, v4, 4, v15
    v_add_u32 v15, s12, v15
    s_lshl_b32 s13, s10, 11
    s_lshl_b32 s14, s8, 6
    s_sub_u32 s13, s13, s14
    s_add_u32 s13, s13, 4032
    v_lshlrev_b32 v16, 12, v3
    v_lshl_add_u32 v16, v4, 4, v16
    v_add_u32 v16, s13, v16
    v_mov_b32 v36, 141324
    v_mov_b32 v37, 1
    s_setprio 2
    s_waitcnt vmcnt(0)
    s_mov_b64 exec, 1
    ds_add_u32 v36, v37
    s_mov_b64 exec, -1
    v_alignbit_b32 v42, v41, v40, 16
    v_lshlrev_b32 v43, 16, v40
    v_lshrrev_b32 v44, 16, v41
L_tile_spin_3:
    ds_read_b32 v38, v36
    s_waitcnt lgkmcnt(0)
    v_readfirstlane_b32 s14, v38
    s_cmp_lt_u32 s14, 5
    s_cbranch_scc1 L_tile_spin_3
L_tproc:
    ds_read_b64_tr_b16 v[18:19], v13 offset:1280
    ds_read_b64_tr_b16 v[26:27], v13 offset:0
    ds_read_b64_tr_b16 v[46:47], v13 offset:12288
    ds_read_b64_tr_b16 v[20:21], v13 offset:3840
    ds_read_b64_tr_b16 v[28:29], v13 offset:2560
    ds_read_b64_tr_b16 v[48:49], v13 offset:14848
    ds_read_b64_tr_b16 v[22:23], v13 offset:6400
    ds_read_b64_tr_b16 v[30:31], v13 offset:5120
    ds_read_b64_tr_b16 v[50:51], v13 offset:17408
    ds_read_b64_tr_b16 v[24:25], v13 offset:8960
    ds_read_b64_tr_b16 v[32:33], v13 offset:7680
    ds_read_b64_tr_b16 v[52:53], v13 offset:19968
    ds_read_b64_tr_b16 v[54:55], v13 offset:22528
    ds_read_b64_tr_b16 v[56:57], v13 offset:25088
    ds_read_b64_tr_b16 v[58:59], v13 offset:27648
    s_waitcnt lgkmcnt(12)
    ds_read_b64_tr_b16 v[60:61], v13 offset:30208
    v_dot2_f32_bf16 v64, v18, v40, 0
    v_dot2_f32_bf16 v65, v18, v43, 0
    v_dot2_f32_bf16 v66, v19, v40, 0
    v_dot2_f32_bf16 v67, v19, v43, 0
    v_dot2_f32_bf16 v64, v19, v41, v64
    v_dot2_f32_bf16 v65, v19, v42, v65
    v_dot2_f32_bf16 v66, v26, v41, v66
    v_dot2_f32_bf16 v67, v26, v42, v67
    v_dot2_f32_bf16 v65, v26, v44, v65
    v_dot2_f32_bf16 v67, v27, v44, v67
    v_lshlrev_b32 v68, 16, v46
    v_and_b32 v69, 0xffff0000, v46
    v_lshlrev_b32 v70, 16, v47
    v_and_b32 v71, 0xffff0000, v47
    v_mul_f32 v64, v64, v68
    v_mul_f32 v65, v65, v69
    v_mul_f32 v66, v66, v70
    v_mul_f32 v67, v67, v71
    v_cvt_pk_bf16_f32 v72, v64, v65
    v_cvt_pk_bf16_f32 v73, v66, v67
    ds_write_b64 v14, v[72:73] offset:2608
    s_waitcnt lgkmcnt(9)
    v_dot2_f32_bf16 v74, v20, v40, 0
    v_dot2_f32_bf16 v75, v20, v43, 0
    v_dot2_f32_bf16 v76, v21, v40, 0
    v_dot2_f32_bf16 v77, v21, v43, 0
    v_dot2_f32_bf16 v74, v21, v41, v74
    v_dot2_f32_bf16 v75, v21, v42, v75
    v_dot2_f32_bf16 v76, v28, v41, v76
    v_dot2_f32_bf16 v77, v28, v42, v77
    v_dot2_f32_bf16 v75, v28, v44, v75
    v_dot2_f32_bf16 v77, v29, v44, v77
    v_lshlrev_b32 v78, 16, v48
    v_and_b32 v79, 0xffff0000, v48
    v_lshlrev_b32 v80, 16, v49
    v_and_b32 v81, 0xffff0000, v49
    v_mul_f32 v74, v74, v78
    v_mul_f32 v75, v75, v79
    v_mul_f32 v76, v76, v80
    v_mul_f32 v77, v77, v81
    v_cvt_pk_bf16_f32 v82, v74, v75
    v_cvt_pk_bf16_f32 v83, v76, v77
    ds_write_b64 v14, v[82:83] offset:2592
    s_waitcnt lgkmcnt(6)
    v_dot2_f32_bf16 v64, v22, v40, 0
    v_dot2_f32_bf16 v65, v22, v43, 0
    v_dot2_f32_bf16 v66, v23, v40, 0
    v_dot2_f32_bf16 v67, v23, v43, 0
    v_dot2_f32_bf16 v64, v23, v41, v64
    v_dot2_f32_bf16 v65, v23, v42, v65
    v_dot2_f32_bf16 v66, v30, v41, v66
    v_dot2_f32_bf16 v67, v30, v42, v67
    v_dot2_f32_bf16 v65, v30, v44, v65
    v_dot2_f32_bf16 v67, v31, v44, v67
    v_lshlrev_b32 v68, 16, v50
    v_and_b32 v69, 0xffff0000, v50
    v_lshlrev_b32 v70, 16, v51
    v_and_b32 v71, 0xffff0000, v51
    v_mul_f32 v64, v64, v68
    v_mul_f32 v65, v65, v69
    v_mul_f32 v66, v66, v70
    v_mul_f32 v67, v67, v71
    v_cvt_pk_bf16_f32 v72, v64, v65
    v_cvt_pk_bf16_f32 v73, v66, v67
    ds_write_b64 v14, v[72:73] offset:2576
    s_waitcnt lgkmcnt(3)
    v_dot2_f32_bf16 v74, v24, v40, 0
    v_dot2_f32_bf16 v75, v24, v43, 0
    v_dot2_f32_bf16 v76, v25, v40, 0
    v_dot2_f32_bf16 v77, v25, v43, 0
    v_dot2_f32_bf16 v74, v25, v41, v74
    v_dot2_f32_bf16 v75, v25, v42, v75
    v_dot2_f32_bf16 v76, v32, v41, v76
    v_dot2_f32_bf16 v77, v32, v42, v77
    v_dot2_f32_bf16 v75, v32, v44, v75
    v_dot2_f32_bf16 v77, v33, v44, v77
    v_lshlrev_b32 v78, 16, v52
    v_and_b32 v79, 0xffff0000, v52
    v_lshlrev_b32 v80, 16, v53
    v_and_b32 v81, 0xffff0000, v53
    v_mul_f32 v74, v74, v78
    v_mul_f32 v75, v75, v79
    v_mul_f32 v76, v76, v80
    v_mul_f32 v77, v77, v81
    v_cvt_pk_bf16_f32 v82, v74, v75
    v_cvt_pk_bf16_f32 v83, v76, v77
    ds_write_b64 v14, v[82:83] offset:2560
    s_waitcnt lgkmcnt(4)
    ds_write_b64 v14, v[54:55] offset:48
    ds_write_b64 v14, v[56:57] offset:32
    ds_write_b64 v14, v[58:59] offset:16
    ds_write_b64 v14, v[60:61] offset:0
    s_waitcnt lgkmcnt(0)
    ds_read_b128 v[18:21], v15 offset:2560
    ds_read_b128 v[22:25], v15 offset:3840
    ds_read_b128 v[26:29], v15 offset:0
    ds_read_b128 v[30:33], v15 offset:1280
    v_add_u32 v17, 2621440, v16
    v_add_u32 v34, 65536, v17
    v_add_u32 v35, 65536, v16
    s_waitcnt lgkmcnt(3)
    buffer_store_dwordx4 v[18:21], v17, s[64:67], 0 offen sc1
    s_waitcnt lgkmcnt(2)
    buffer_store_dwordx4 v[22:25], v34, s[64:67], 0 offen sc1
    s_waitcnt lgkmcnt(1)
    buffer_store_dwordx4 v[26:29], v16, s[64:67], 0 offen sc1
    s_waitcnt lgkmcnt(0)
    buffer_store_dwordx4 v[30:33], v35, s[64:67], 0 offen sc1
    s_endpgm
L_kgen:
    s_mul_i32 s8, s6, 9216
    s_add_u32 s8, s8, 58368
    s_mov_b32 s72, s46
    s_and_b32 s73, s47, 0xffff
    s_mov_b32 s74, 10485760
    s_mov_b32 s75, 0x00020000
    s_mov_b32 m0, s8
    v_and_b32 v5, 15, v2
    v_lshrrev_b32 v6, 4, v2
    v_mul_u32_u24 v7, 288, v5
    v_lshl_add_u32 v7, v6, 4, v7
    v_add_u32 v7, s8, v7
    v_lshlrev_b32 v8, 4, v2
    v_add_u32 v9, s8, v8
    v_lshlrev_b32 v60, 4, v5
    v_add_u32 v60, s8, v60
    v_and_b32 v61, 1, v6
    v_lshrrev_b32 v62, 1, v6
    v_lshl_add_u32 v56, v61, 3, v60
    v_lshl_add_u32 v56, v62, 8, v56
    v_lshl_add_u32 v57, v6, 8, v60
    v_add_u32 v57, 512, v57
    v_lshl_add_u32 v58, v6, 9, v60
    v_cmp_gt_u32 vcc, 2, v6
    v_mov_b32 v61, 8
    v_mov_b32 v62, 4
    v_cndmask_b32 v57, v58, v57, vcc
    v_cndmask_b32 v61, v61, v62, vcc
    v_add_u32 v58, v57, v61
    v_mov_b32 v61, 256
    v_mov_b32 v62, 8
    v_cndmask_b32 v61, v61, v62, vcc
    v_add_u32 v59, v57, v61
    v_mov_b32 v61, 264
    v_mov_b32 v62, 12
    v_cndmask_b32 v61, v61, v62, vcc
    v_add_u32 v124, v57, v61
    v_lshl_add_u32 v61, v6, 10, v60
    v_add_u32 v61, 2048, v61
    v_lshlrev_b32 v62, 1, v2
    v_add_u32 v62, s8, v62
    v_add_u32 v62, 5120, v62
    v_cndmask_b32 v126, v62, v61, vcc
    v_cmp_gt_u32 vcc, 3, v6
    s_nop 1
    v_cndmask_b32 v125, v62, v61, vcc
    v_and_b32 v60, 1, v2
    v_cmp_eq_u32 vcc, 1, v60
    v_mov_b32 v61, 0x05040100
    v_mov_b32 v62, 0x05040504
    v_cndmask_b32 v127, v61, v62, vcc
    s_mul_i32 s6, s5, 4096
    s_add_u32 s6, s6, 5242880
    v_add_u32 v63, s6, v8
    s_mov_b32 s12, 0x01000100
    s_mov_b32 s13, 0x05040100
    s_mov_b32 s9, 0x3fb8aa3b
    s_mov_b32 s10, 0x3e22f983
    s_waitcnt lgkmcnt(0)
    s_and_b32 s66, s5, 1
    s_lshl_b32 s66, s66, 4
    s_lshr_b32 s64, s64, s66
    s_lshl_b32 s64, s64, 16
    s_lshr_b32 s65, s65, s66
    s_lshl_b32 s65, s65, 16
    v_mov_b32 v14, s64
    v_mov_b32 v15, s65
    v_cmp_eq_u32 vcc, 0, v2
    s_nop 1
    v_cndmask_b32 v15, 0, v15, vcc
    v_cmp_gt_u32 vcc, 32, v2
    s_waitcnt vmcnt(0)
    s_branch L_nopf_4
    s_cmp_lg_u32 s4, 1
    s_cbranch_scc1 L_nopf_4
    s_cmp_lg_u32 s67, 1
    s_cbranch_scc1 L_nopf_4
    s_cmp_eq_u32 s67, 1
    s_cselect_b32 s68, s30, s38
    s_cselect_b32 s69, s31, s39
    s_and_b32 s69, s69, 0xffff
    s_mov_b32 s70, 2621440
    s_mov_b32 s71, 0x00020000
    s_mul_i32 s15, s2, 10240
    v_lshlrev_b32 v60, 7, v2
    v_add_u32 v60, s15, v60
    buffer_load_dword v56, v60, s[68:71], 0 offen
    s_mov_b32 exec_lo, 0xffff
    s_mov_b32 exec_hi, 0
    v_add_u32 v60, 8192, v60
    buffer_load_dword v57, v60, s[68:71], 0 offen
    s_mov_b64 exec, -1
L_nopf_4:
    s_cmp_lg_u32 s4, 2
    s_cbranch_scc1 L_nocp_5
    s_cmp_lg_u32 s67, 0
    s_cbranch_scc1 L_nocp_5
    s_cmp_ge_u32 s2, 8
    s_cbranch_scc1 L_nocp_5
    s_getpc_b64 s[68:69]
L_pc_6:
    v_lshlrev_b32 v60, 7, v2
    v_add_u32 v60, conv_kernel-L_pc_6, v60
    v_min_u32 v61, L_conv_exit-L_pc_6, v60
    global_load_dword v57, v61, s[68:69]
    v_add_u32 v60, 8192, v60
    v_min_u32 v61, L_conv_exit-L_pc_6, v60
    global_load_dword v58, v61, s[68:69]
    v_add_u32 v60, 8192, v60
    v_min_u32 v61, L_conv_exit-L_pc_6, v60
    global_load_dword v59, v61, s[68:69]
    v_add_u32 v60, 8192, v60
L_nocp_5:
    s_setprio 0
    v_mul_f32 v14, s9, v14
    v_mul_f32 v10, s9, v10
    v_exp_f32 v14, v14
    v_exp_f32 v10, v10
    s_nop 0
    v_cvt_pk_bf16_f32 v14, v14, v10
    v_and_b32 v10, 0xffff0000, v14
    v_lshlrev_b32 v14, 16, v14
    v_mul_f32 v10, v10, v14
    v_mul_f32 v11, v11, v14
    v_add_f32 v14, v14, v14
    v_mul_f32 v32, v12, v14
    v_mul_f32 v33, v13, v14
    v_mul_f32 v10, s9, v10
    v_sub_f32 v10, 0, v10
    v_mul_f32 v11, s10, v11
    v_rndne_f32 v26, v11
    v_exp_f32 v24, v10
    v_sub_f32 v25, v11, v26
    v_cos_f32 v26, v25
    v_sin_f32 v25, v25
    s_nop 0
    v_mul_f32 v18, v24, v26
    v_mul_f32 v19, v24, v25
    v_mul_f32 v24, 0x41000000, v10
    v_mul_f32 v25, 0x41000000, v11
    v_rndne_f32 v26, v25
    v_exp_f32 v24, v24
    v_sub_f32 v25, v25, v26
    v_cos_f32 v26, v25
    v_sin_f32 v25, v25
    s_nop 0
    v_mul_f32 v20, v24, v26
    v_mul_f32 v21, v24, v25
    v_mul_f32 v24, 0x43000000, v10
    v_mul_f32 v25, 0x43000000, v11
    v_rndne_f32 v26, v25
    v_exp_f32 v24, v24
    v_sub_f32 v25, v25, v26
    v_cos_f32 v26, v25
    v_sin_f32 v25, v25
    s_nop 0
    v_mul_f32 v22, v24, v26
    v_mul_f32 v23, v24, v25
    v_mov_b32 v52, 0x3f80
    ds_write_addtid_b32 v52 offset:0
    v_cvt_pk_bf16_f32 v53, v20, -v21
    ds_write_addtid_b32 v53 offset:288
    v_pk_mul_f32 v[24:25], v[20:21], v[20:21] op_sel:[0,0] op_sel_hi:[0,1]
    v_pk_mul_f32 v[26:27], v[32:33], v[18:19] op_sel:[0,0] op_sel_hi:[0,1]
    v_pk_fma_f32 v[50:51], v[20:21], v[20:21], v[24:25] op_sel:[1,1,0] op_sel_hi:[1,0,1] neg_lo:[0,1,0]
    v_pk_fma_f32 v[34:35], v[32:33], v[18:19], v[26:27] op_sel:[1,1,0] op_sel_hi:[1,0,1] neg_lo:[0,1,0]
    v_cvt_pk_bf16_f32 v54, v32, v33
    ds_write_addtid_b32 v54 offset:4608
    v_cvt_pk_bf16_f32 v53, v50, -v51
    ds_write_addtid_b32 v53 offset:576
    v_pk_mul_f32 v[24:25], v[50:51], v[20:21] op_sel:[0,0] op_sel_hi:[0,1]
    v_pk_mul_f32 v[26:27], v[34:35], v[18:19] op_sel:[0,0] op_sel_hi:[0,1]
    v_pk_fma_f32 v[50:51], v[50:51], v[20:21], v[24:25] op_sel:[1,1,0] op_sel_hi:[1,0,1] neg_lo:[0,1,0]
    v_pk_fma_f32 v[36:37], v[34:35], v[18:19], v[26:27] op_sel:[1,1,0] op_sel_hi:[1,0,1] neg_lo:[0,1,0]
    v_cvt_pk_bf16_f32 v54, v34, v35
    ds_write_addtid_b32 v54 offset:4896
    v_cvt_pk_bf16_f32 v53, v50, -v51
    ds_write_addtid_b32 v53 offset:864
    v_pk_mul_f32 v[24:25], v[50:51], v[20:21] op_sel:[0,0] op_sel_hi:[0,1]
    v_pk_mul_f32 v[26:27], v[36:37], v[18:19] op_sel:[0,0] op_sel_hi:[0,1]
    v_pk_fma_f32 v[50:51], v[50:51], v[20:21], v[24:25] op_sel:[1,1,0] op_sel_hi:[1,0,1] neg_lo:[0,1,0]
    v_pk_fma_f32 v[38:39], v[36:37], v[18:19], v[26:27] op_sel:[1,1,0] op_sel_hi:[1,0,1] neg_lo:[0,1,0]
    v_cvt_pk_bf16_f32 v54, v36, v37
    ds_write_addtid_b32 v54 offset:5184
    v_cvt_pk_bf16_f32 v53, v50, -v51
    ds_write_addtid_b32 v53 offset:1152
    v_pk_mul_f32 v[24:25], v[50:51], v[20:21] op_sel:[0,0] op_sel_hi:[0,1]
    v_pk_mul_f32 v[26:27], v[38:39], v[18:19] op_sel:[0,0] op_sel_hi:[0,1]
    v_pk_fma_f32 v[50:51], v[50:51], v[20:21], v[24:25] op_sel:[1,1,0] op_sel_hi:[1,0,1] neg_lo:[0,1,0]
    v_pk_fma_f32 v[40:41], v[38:39], v[18:19], v[26:27] op_sel:[1,1,0] op_sel_hi:[1,0,1] neg_lo:[0,1,0]
    v_cvt_pk_bf16_f32 v54, v38, v39
    ds_write_addtid_b32 v54 offset:5472
    v_cvt_pk_bf16_f32 v53, v50, -v51
    ds_write_addtid_b32 v53 offset:1440
    v_pk_mul_f32 v[24:25], v[50:51], v[20:21] op_sel:[0,0] op_sel_hi:[0,1]
    v_pk_mul_f32 v[26:27], v[40:41], v[18:19] op_sel:[0,0] op_sel_hi:[0,1]
    v_pk_fma_f32 v[50:51], v[50:51], v[20:21], v[24:25] op_sel:[1,1,0] op_sel_hi:[1,0,1] neg_lo:[0,1,0]
    v_pk_fma_f32 v[42:43], v[40:41], v[18:19], v[26:27] op_sel:[1,1,0] op_sel_hi:[1,0,1] neg_lo:[0,1,0]
    v_cvt_pk_bf16_f32 v54, v40, v41
    ds_write_addtid_b32 v54 offset:5760
    v_cvt_pk_bf16_f32 v53, v50, -v51
    ds_write_addtid_b32 v53 offset:1728
    v_pk_mul_f32 v[24:25], v[50:51], v[20:21] op_sel:[0,0] op_sel_hi:[0,1]
    v_pk_mul_f32 v[26:27], v[42:43], v[18:19] op_sel:[0,0] op_sel_hi:[0,1]
    v_pk_fma_f32 v[50:51], v[50:51], v[20:21], v[24:25] op_sel:[1,1,0] op_sel_hi:[1,0,1] neg_lo:[0,1,0]
    v_pk_fma_f32 v[44:45], v[42:43], v[18:19], v[26:27] op_sel:[1,1,0] op_sel_hi:[1,0,1] neg_lo:[0,1,0]
    v_cvt_pk_bf16_f32 v54, v42, v43
    ds_write_addtid_b32 v54 offset:6048
    v_cvt_pk_bf16_f32 v53, v50, -v51
    ds_write_addtid_b32 v53 offset:2016
    v_pk_mul_f32 v[24:25], v[50:51], v[20:21] op_sel:[0,0] op_sel_hi:[0,1]
    v_pk_mul_f32 v[26:27], v[44:45], v[18:19] op_sel:[0,0] op_sel_hi:[0,1]
    v_pk_fma_f32 v[50:51], v[50:51], v[20:21], v[24:25] op_sel:[1,1,0] op_sel_hi:[1,0,1] neg_lo:[0,1,0]
    v_pk_fma_f32 v[46:47], v[44:45], v[18:19], v[26:27] op_sel:[1,1,0] op_sel_hi:[1,0,1] neg_lo:[0,1,0]
    v_cvt_pk_bf16_f32 v54, v44, v45
    ds_write_addtid_b32 v54 offset:6336
    v_cvt_pk_bf16_f32 v53, v50, -v51
    ds_write_addtid_b32 v53 offset:2304
    v_pk_mul_f32 v[24:25], v[50:51], v[20:21] op_sel:[0,0] op_sel_hi:[0,1]
    v_pk_fma_f32 v[50:51], v[50:51], v[20:21], v[24:25] op_sel:[1,1,0] op_sel_hi:[1,0,1] neg_lo:[0,1,0]
    v_cvt_pk_bf16_f32 v54, v46, v47
    ds_write_addtid_b32 v54 offset:6624
    v_pk_mul_f32 v[26:27], v[32:33], v[22:23] op_sel:[0,0] op_sel_hi:[0,1]
    v_pk_fma_f32 v[32:33], v[32:33], v[22:23], v[26:27] op_sel:[1,1,0] op_sel_hi:[1,0,1] neg_lo:[0,1,0]
    v_cvt_pk_bf16_f32 v54, v32, v33
    ds_write_addtid_b32 v54 offset:6912
    v_cvt_pk_bf16_f32 v53, v50, -v51
    ds_write_addtid_b32 v53 offset:2592
    v_pk_mul_f32 v[24:25], v[50:51], v[20:21] op_sel:[0,0] op_sel_hi:[0,1]
    v_pk_fma_f32 v[50:51], v[50:51], v[20:21], v[24:25] op_sel:[1,1,0] op_sel_hi:[1,0,1] neg_lo:[0,1,0]
    v_pk_mul_f32 v[26:27], v[34:35], v[22:23] op_sel:[0,0] op_sel_hi:[0,1]
    v_pk_fma_f32 v[34:35], v[34:35], v[22:23], v[26:27] op_sel:[1,1,0] op_sel_hi:[1,0,1] neg_lo:[0,1,0]
    v_cvt_pk_bf16_f32 v54, v34, v35
    ds_write_addtid_b32 v54 offset:7200
    v_cvt_pk_bf16_f32 v53, v50, -v51
    ds_write_addtid_b32 v53 offset:2880
    v_pk_mul_f32 v[24:25], v[50:51], v[20:21] op_sel:[0,0] op_sel_hi:[0,1]
    v_pk_fma_f32 v[50:51], v[50:51], v[20:21], v[24:25] op_sel:[1,1,0] op_sel_hi:[1,0,1] neg_lo:[0,1,0]
    v_pk_mul_f32 v[26:27], v[36:37], v[22:23] op_sel:[0,0] op_sel_hi:[0,1]
    v_pk_fma_f32 v[36:37], v[36:37], v[22:23], v[26:27] op_sel:[1,1,0] op_sel_hi:[1,0,1] neg_lo:[0,1,0]
    v_cvt_pk_bf16_f32 v54, v36, v37
    ds_write_addtid_b32 v54 offset:7488
    v_cvt_pk_bf16_f32 v53, v50, -v51
    ds_write_addtid_b32 v53 offset:3168
    v_pk_mul_f32 v[24:25], v[50:51], v[20:21] op_sel:[0,0] op_sel_hi:[0,1]
    v_pk_fma_f32 v[50:51], v[50:51], v[20:21], v[24:25] op_sel:[1,1,0] op_sel_hi:[1,0,1] neg_lo:[0,1,0]
    v_pk_mul_f32 v[26:27], v[38:39], v[22:23] op_sel:[0,0] op_sel_hi:[0,1]
    v_pk_fma_f32 v[38:39], v[38:39], v[22:23], v[26:27] op_sel:[1,1,0] op_sel_hi:[1,0,1] neg_lo:[0,1,0]
    v_cvt_pk_bf16_f32 v54, v38, v39
    ds_write_addtid_b32 v54 offset:7776
    v_cvt_pk_bf16_f32 v53, v50, -v51
    ds_write_addtid_b32 v53 offset:3456
    v_pk_mul_f32 v[24:25], v[50:51], v[20:21] op_sel:[0,0] op_sel_hi:[0,1]
    v_pk_fma_f32 v[50:51], v[50:51], v[20:21], v[24:25] op_sel:[1,1,0] op_sel_hi:[1,0,1] neg_lo:[0,1,0]
    v_pk_mul_f32 v[26:27], v[40:41], v[22:23] op_sel:[0,0] op_sel_hi:[0,1]
    v_pk_fma_f32 v[40:41], v[40:41], v[22:23], v[26:27] op_sel:[1,1,0] op_sel_hi:[1,0,1] neg_lo:[0,1,0]
    v_cvt_pk_bf16_f32 v54, v40, v41
    ds_write_addtid_b32 v54 offset:8064
    v_cvt_pk_bf16_f32 v53, v50, -v51
    ds_write_addtid_b32 v53 offset:3744
    v_pk_mul_f32 v[24:25], v[50:51], v[20:21] op_sel:[0,0] op_sel_hi:[0,1]
    v_pk_fma_f32 v[50:51], v[50:51], v[20:21], v[24:25] op_sel:[1,1,0] op_sel_hi:[1,0,1] neg_lo:[0,1,0]
    v_pk_mul_f32 v[26:27], v[42:43], v[22:23] op_sel:[0,0] op_sel_hi:[0,1]
    v_pk_fma_f32 v[42:43], v[42:43], v[22:23], v[26:27] op_sel:[1,1,0] op_sel_hi:[1,0,1] neg_lo:[0,1,0]
    v_cvt_pk_bf16_f32 v54, v42, v43
    ds_write_addtid_b32 v54 offset:8352
    v_cvt_pk_bf16_f32 v53, v50, -v51
    ds_write_addtid_b32 v53 offset:4032
    v_pk_mul_f32 v[24:25], v[50:51], v[20:21] op_sel:[0,0] op_sel_hi:[0,1]
    v_pk_fma_f32 v[50:51], v[50:51], v[20:21], v[24:25] op_sel:[1,1,0] op_sel_hi:[1,0,1] neg_lo:[0,1,0]
    v_pk_mul_f32 v[26:27], v[44:45], v[22:23] op_sel:[0,0] op_sel_hi:[0,1]
    v_pk_fma_f32 v[44:45], v[44:45], v[22:23], v[26:27] op_sel:[1,1,0] op_sel_hi:[1,0,1] neg_lo:[0,1,0]
    v_cvt_pk_bf16_f32 v54, v44, v45
    ds_write_addtid_b32 v54 offset:8640
    v_cvt_pk_bf16_f32 v53, v50, -v51
    ds_write_addtid_b32 v53 offset:4320
    v_pk_mul_f32 v[26:27], v[46:47], v[22:23] op_sel:[0,0] op_sel_hi:[0,1]
    v_pk_fma_f32 v[46:47], v[46:47], v[22:23], v[26:27] op_sel:[1,1,0] op_sel_hi:[1,0,1] neg_lo:[0,1,0]
    v_cvt_pk_bf16_f32 v54, v46, v47
    ds_write_addtid_b32 v54 offset:8928
    s_waitcnt lgkmcnt(0)
    ds_read_b128 v[64:67], v7 offset:0
    ds_read_b128 v[68:71], v7 offset:64
    ds_read_b128 v[72:75], v7 offset:128
    ds_read_b128 v[76:79], v7 offset:192
    ds_read_b128 v[80:83], v7 offset:4608
    ds_read_b128 v[84:87], v7 offset:4672
    ds_read_b128 v[88:91], v7 offset:4736
    ds_read_b128 v[92:95], v7 offset:4800
    v_pk_mul_f32 v[24:25], v[32:33], v[22:23] op_sel:[0,0] op_sel_hi:[0,1]
    v_pk_fma_f32 v[32:33], v[32:33], v[22:23], v[24:25] op_sel:[1,1,0] op_sel_hi:[1,0,1] neg_lo:[0,1,0]
    v_pk_mul_f32 v[26:27], v[36:37], v[22:23] op_sel:[0,0] op_sel_hi:[0,1]
    v_pk_fma_f32 v[36:37], v[36:37], v[22:23], v[26:27] op_sel:[1,1,0] op_sel_hi:[1,0,1] neg_lo:[0,1,0]
    v_pk_mul_f32 v[28:29], v[40:41], v[22:23] op_sel:[0,0] op_sel_hi:[0,1]
    v_pk_fma_f32 v[40:41], v[40:41], v[22:23], v[28:29] op_sel:[1,1,0] op_sel_hi:[1,0,1] neg_lo:[0,1,0]
    v_pk_mul_f32 v[30:31], v[44:45], v[22:23] op_sel:[0,0] op_sel_hi:[0,1]
    v_pk_fma_f32 v[44:45], v[44:45], v[22:23], v[30:31] op_sel:[1,1,0] op_sel_hi:[1,0,1] neg_lo:[0,1,0]
    s_waitcnt lgkmcnt(4)
    v_cvt_pk_bf16_f32 v52, v32, v33
    ds_write_addtid_b32 v52 offset:0
    v_cvt_pk_bf16_f32 v53, v36, v37
    ds_write_addtid_b32 v53 offset:288
    v_cvt_pk_bf16_f32 v54, v40, v41
    ds_write_addtid_b32 v54 offset:576
    v_cvt_pk_bf16_f32 v55, v44, v45
    ds_write_addtid_b32 v55 offset:864
    v_pk_mul_f32 v[24:25], v[32:33], v[22:23] op_sel:[0,0] op_sel_hi:[0,1]
    v_pk_fma_f32 v[32:33], v[32:33], v[22:23], v[24:25] op_sel:[1,1,0] op_sel_hi:[1,0,1] neg_lo:[0,1,0]
    v_pk_mul_f32 v[26:27], v[36:37], v[22:23] op_sel:[0,0] op_sel_hi:[0,1]
    v_pk_fma_f32 v[36:37], v[36:37], v[22:23], v[26:27] op_sel:[1,1,0] op_sel_hi:[1,0,1] neg_lo:[0,1,0]
    v_pk_mul_f32 v[28:29], v[40:41], v[22:23] op_sel:[0,0] op_sel_hi:[0,1]
    v_pk_fma_f32 v[40:41], v[40:41], v[22:23], v[28:29] op_sel:[1,1,0] op_sel_hi:[1,0,1] neg_lo:[0,1,0]
    v_pk_mul_f32 v[30:31], v[44:45], v[22:23] op_sel:[0,0] op_sel_hi:[0,1]
    v_pk_fma_f32 v[44:45], v[44:45], v[22:23], v[30:31] op_sel:[1,1,0] op_sel_hi:[1,0,1] neg_lo:[0,1,0]
    s_waitcnt lgkmcnt(4)
    v_mfma_f32_16x16x32_bf16 v[96:99], v[80:83], v[64:67], 0
    v_mfma_f32_16x16x32_bf16 v[96:99], v[84:87], v[68:71], v[96:99]
    v_mfma_f32_16x16x32_bf16 v[96:99], v[88:91], v[72:75], v[96:99]
    v_mfma_f32_16x16x32_bf16 v[96:99], v[92:95], v[76:79], v[96:99]
    v_cvt_pk_bf16_f32 v52, v32, v33
    ds_write_addtid_b32 v52 offset:1152
    v_cvt_pk_bf16_f32 v53, v36, v37
    ds_write_addtid_b32 v53 offset:1440
    v_cvt_pk_bf16_f32 v54, v40, v41
    ds_write_addtid_b32 v54 offset:1728
    v_cvt_pk_bf16_f32 v55, v44, v45
    ds_write_addtid_b32 v55 offset:2016
    v_pk_mul_f32 v[24:25], v[32:33], v[22:23] op_sel:[0,0] op_sel_hi:[0,1]
    v_pk_fma_f32 v[32:33], v[32:33], v[22:23], v[24:25] op_sel:[1,1,0] op_sel_hi:[1,0,1] neg_lo:[0,1,0]
    v_pk_mul_f32 v[26:27], v[40:41], v[22:23] op_sel:[0,0] op_sel_hi:[0,1]
    v_pk_fma_f32 v[40:41], v[40:41], v[22:23], v[26:27] op_sel:[1,1,0] op_sel_hi:[1,0,1] neg_lo:[0,1,0]
    v_cvt_pk_bf16_f32 v52, v32, v33
    ds_write_addtid_b32 v52 offset:2304
    v_cvt_pk_bf16_f32 v53, v40, v41
    ds_write_addtid_b32 v53 offset:2592
    v_pk_mul_f32 v[24:25], v[32:33], v[22:23] op_sel:[0,0] op_sel_hi:[0,1]
    v_pk_fma_f32 v[32:33], v[32:33], v[22:23], v[24:25] op_sel:[1,1,0] op_sel_hi:[1,0,1] neg_lo:[0,1,0]
    v_pk_mul_f32 v[26:27], v[40:41], v[22:23] op_sel:[0,0] op_sel_hi:[0,1]
    v_pk_fma_f32 v[40:41], v[40:41], v[22:23], v[26:27] op_sel:[1,1,0] op_sel_hi:[1,0,1] neg_lo:[0,1,0]
    v_cvt_pk_bf16_f32 v54, v32, v33
    ds_write_addtid_b32 v54 offset:2880
    v_cvt_pk_bf16_f32 v55, v40, v41
    ds_write_addtid_b32 v55 offset:3168
    v_pk_mul_f32 v[24:25], v[32:33], v[22:23] op_sel:[0,0] op_sel_hi:[0,1]
    v_pk_fma_f32 v[32:33], v[32:33], v[22:23], v[24:25] op_sel:[1,1,0] op_sel_hi:[1,0,1] neg_lo:[0,1,0]
    v_pk_mul_f32 v[26:27], v[40:41], v[22:23] op_sel:[0,0] op_sel_hi:[0,1]
    v_pk_fma_f32 v[40:41], v[40:41], v[22:23], v[26:27] op_sel:[1,1,0] op_sel_hi:[1,0,1] neg_lo:[0,1,0]
    v_cvt_pk_bf16_f32 v52, v32, v33
    ds_write_addtid_b32 v52 offset:3456
    v_cvt_pk_bf16_f32 v53, v40, v41
    ds_write_addtid_b32 v53 offset:3744
    v_pk_mul_f32 v[24:25], v[32:33], v[22:23] op_sel:[0,0] op_sel_hi:[0,1]
    v_pk_fma_f32 v[32:33], v[32:33], v[22:23], v[24:25] op_sel:[1,1,0] op_sel_hi:[1,0,1] neg_lo:[0,1,0]
    v_pk_mul_f32 v[26:27], v[40:41], v[22:23] op_sel:[0,0] op_sel_hi:[0,1]
    v_pk_fma_f32 v[40:41], v[40:41], v[22:23], v[26:27] op_sel:[1,1,0] op_sel_hi:[1,0,1] neg_lo:[0,1,0]
    v_cvt_pk_bf16_f32 v54, v32, v33
    ds_write_addtid_b32 v54 offset:4032
    v_cvt_pk_bf16_f32 v55, v40, v41
    ds_write_addtid_b32 v55 offset:4320
    v_pk_mul_f32 v[24:25], v[32:33], v[22:23] op_sel:[0,0] op_sel_hi:[0,1]
    v_pk_fma_f32 v[32:33], v[32:33], v[22:23], v[24:25] op_sel:[1,1,0] op_sel_hi:[1,0,1] neg_lo:[0,1,0]
    v_cvt_pk_bf16_f32 v52, v32, v33
    ds_write_addtid_b32 v52 offset:4608
    v_pk_mul_f32 v[26:27], v[32:33], v[22:23] op_sel:[0,0] op_sel_hi:[0,1]
    v_pk_fma_f32 v[32:33], v[32:33], v[22:23], v[26:27] op_sel:[1,1,0] op_sel_hi:[1,0,1] neg_lo:[0,1,0]
    v_cvt_pk_bf16_f32 v53, v32, v33
    ds_write_addtid_b32 v53 offset:4896
    v_pk_mul_f32 v[24:25], v[32:33], v[22:23] op_sel:[0,0] op_sel_hi:[0,1]
    v_pk_fma_f32 v[32:33], v[32:33], v[22:23], v[24:25] op_sel:[1,1,0] op_sel_hi:[1,0,1] neg_lo:[0,1,0]
    v_cvt_pk_bf16_f32 v54, v32, v33
    ds_write_addtid_b32 v54 offset:5184
    v_pk_mul_f32 v[26:27], v[32:33], v[22:23] op_sel:[0,0] op_sel_hi:[0,1]
    v_pk_fma_f32 v[32:33], v[32:33], v[22:23], v[26:27] op_sel:[1,1,0] op_sel_hi:[1,0,1] neg_lo:[0,1,0]
    v_cvt_pk_bf16_f32 v55, v32, v33
    ds_write_addtid_b32 v55 offset:5472
    v_pk_mul_f32 v[24:25], v[32:33], v[22:23] op_sel:[0,0] op_sel_hi:[0,1]
    v_pk_fma_f32 v[32:33], v[32:33], v[22:23], v[24:25] op_sel:[1,1,0] op_sel_hi:[1,0,1] neg_lo:[0,1,0]
    v_cvt_pk_bf16_f32 v52, v32, v33
    ds_write_addtid_b32 v52 offset:5760
    v_pk_mul_f32 v[26:27], v[32:33], v[22:23] op_sel:[0,0] op_sel_hi:[0,1]
    v_pk_fma_f32 v[32:33], v[32:33], v[22:23], v[26:27] op_sel:[1,1,0] op_sel_hi:[1,0,1] neg_lo:[0,1,0]
    v_cvt_pk_bf16_f32 v53, v32, v33
    ds_write_addtid_b32 v53 offset:6048
    v_pk_mul_f32 v[24:25], v[32:33], v[22:23] op_sel:[0,0] op_sel_hi:[0,1]
    v_pk_fma_f32 v[32:33], v[32:33], v[22:23], v[24:25] op_sel:[1,1,0] op_sel_hi:[1,0,1] neg_lo:[0,1,0]
    v_cvt_pk_bf16_f32 v54, v32, v33
    ds_write_addtid_b32 v54 offset:6336
    v_pk_mul_f32 v[26:27], v[32:33], v[22:23] op_sel:[0,0] op_sel_hi:[0,1]
    v_pk_fma_f32 v[32:33], v[32:33], v[22:23], v[26:27] op_sel:[1,1,0] op_sel_hi:[1,0,1] neg_lo:[0,1,0]
    v_cvt_pk_bf16_f32 v55, v32, v33
    ds_write_addtid_b32 v55 offset:6624
    v_pk_mul_f32 v[24:25], v[32:33], v[22:23] op_sel:[0,0] op_sel_hi:[0,1]
    v_pk_fma_f32 v[32:33], v[32:33], v[22:23], v[24:25] op_sel:[1,1,0] op_sel_hi:[1,0,1] neg_lo:[0,1,0]
    v_cvt_pk_bf16_f32 v52, v32, v33
    ds_write_addtid_b32 v52 offset:6912
    s_waitcnt lgkmcnt(9)
    ds_read_b128 v[80:83], v7 offset:0
    ds_read_b128 v[84:87], v7 offset:64
    ds_read_b128 v[88:91], v7 offset:128
    ds_read_b128 v[92:95], v7 offset:192
    s_waitcnt lgkmcnt(0)
    v_mfma_f32_16x16x32_bf16 v[100:103], v[80:83], v[64:67], 0
    v_mfma_f32_16x16x32_bf16 v[100:103], v[84:87], v[68:71], v[100:103]
    v_mfma_f32_16x16x32_bf16 v[100:103], v[88:91], v[72:75], v[100:103]
    v_mfma_f32_16x16x32_bf16 v[100:103], v[92:95], v[76:79], v[100:103]
    ds_read_b128 v[108:111], v7 offset:4608
    ds_read_b128 v[112:115], v7 offset:4672
    ds_read_b128 v[116:119], v7 offset:4736
    ds_read_b128 v[120:123], v7 offset:4800
    s_waitcnt lgkmcnt(0)
    v_mfma_f32_16x16x32_bf16 v[104:107], v[108:111], v[64:67], 0
    v_mfma_f32_16x16x32_bf16 v[104:107], v[112:115], v[68:71], v[104:107]
    v_mfma_f32_16x16x32_bf16 v[104:107], v[116:119], v[72:75], v[104:107]
    v_mfma_f32_16x16x32_bf16 v[104:107], v[120:123], v[76:79], v[104:107]
    s_nop 7
    s_nop 1
    s_cmp_eq_u32 s4, 0
    s_cbranch_scc1 L_kg_w0_7
    ds_write_b128 v9, v[96:99] offset:0
    ds_write_b128 v9, v[100:103] offset:1024
    ds_write_b128 v9, v[104:107] offset:2048
    s_lshl_b32 s15, s67, 2
    s_add_u32 s15, s15, 141312
    v_mov_b32 v10, s15
    v_mov_b32 v11, 1
    s_waitcnt lgkmcnt(0)
    s_mov_b64 exec, 1
    ds_add_u32 v10, v11
    s_mov_b64 exec, -1
    s_endpgm
L_kg_w0_7:
    s_lshl_b32 s15, s67, 2
    s_add_u32 s15, s15, 141312
    v_mov_b32 v10, s15
L_kg_spin_8:
    ds_read_b32 v11, v10
    s_waitcnt lgkmcnt(0)
    v_readfirstlane_b32 s14, v11
    s_cmp_lt_u32 s14, 2
    s_cbranch_scc1 L_kg_spin_8
    s_setprio 3
    ds_read_b128 v[32:35], v9 offset:9216
    ds_read_b128 v[36:39], v9 offset:10240
    ds_read_b128 v[40:43], v9 offset:11264
    ds_read_b128 v[44:47], v9 offset:18432
    ds_read_b128 v[48:51], v9 offset:19456
    ds_read_b128 v[52:55], v9 offset:20480
    s_waitcnt lgkmcnt(0)
    v_add_f32 v96, v96, v32
    v_add_f32 v97, v97, v33
    v_add_f32 v98, v98, v34
    v_add_f32 v99, v99, v35
    v_add_f32 v100, v100, v36
    v_add_f32 v101, v101, v37
    v_add_f32 v102, v102, v38
    v_add_f32 v103, v103, v39
    v_add_f32 v104, v104, v40
    v_add_f32 v105, v105, v41
    v_add_f32 v106, v106, v42
    v_add_f32 v107, v107, v43
    v_add_f32 v96, v96, v44
    v_add_f32 v97, v97, v45
    v_add_f32 v98, v98, v46
    v_add_f32 v99, v99, v47
    v_add_f32 v100, v100, v48
    v_add_f32 v101, v101, v49
    v_add_f32 v102, v102, v50
    v_add_f32 v103, v103, v51
    v_add_f32 v104, v104, v52
    v_add_f32 v105, v105, v53
    v_add_f32 v106, v106, v54
    v_add_f32 v107, v107, v55
    v_add_f32 v96, v96, v15
    v_cvt_pk_bf16_f32 v32, v96, v97
    v_cvt_pk_bf16_f32 v33, v98, v99
    v_cvt_pk_bf16_f32 v34, v100, v101
    v_cvt_pk_bf16_f32 v35, v102, v103
    v_cvt_pk_bf16_f32 v36, v104, v105
    v_cvt_pk_bf16_f32 v37, v106, v107
    ds_write_b16 v56, v32 offset:0
    ds_write_b16_d16_hi v56, v32 offset:2
    ds_write_b16 v56, v33 offset:4
    ds_write_b16_d16_hi v56, v33 offset:6
    ds_write_b16 v57, v34
    ds_write_b16_d16_hi v58, v34
    ds_write_b16 v59, v35
    ds_write_b16_d16_hi v124, v35
    ds_write_b16 v125, v36 offset:0
    ds_write_b16_d16_hi v126, v36 offset:256
    ds_write_b16 v126, v37 offset:512
    ds_write_b16_d16_hi v126, v37 offset:768
    s_waitcnt lgkmcnt(0)
    ds_read_b128 v[40:43], v9 offset:0
    ds_read_b32 v44, v9 offset:16
    ds_read_b128 v[48:51], v9 offset:1024
    ds_read_b32 v52, v9 offset:1040
    ds_read_b128 v[64:67], v9 offset:2048
    ds_read_b32 v68, v9 offset:2064
    ds_read_b128 v[70:73], v9 offset:3072
    ds_read_b32 v74, v9 offset:3088
    s_waitcnt lgkmcnt(0)
    v_perm_b32 v76, v40, v40, s12
    v_perm_b32 v77, v42, v41, s13
    v_perm_b32 v78, v42, v42, s12
    v_perm_b32 v79, v44, v43, s13
    v_cndmask_b32 v76, v76, v40, vcc
    v_cndmask_b32 v77, v77, v41, vcc
    v_cndmask_b32 v78, v78, v42, vcc
    v_cndmask_b32 v79, v79, v43, vcc
    v_perm_b32 v80, v48, v48, s12
    v_perm_b32 v81, v50, v48, s13
    v_perm_b32 v82, v50, v50, s12
    v_perm_b32 v83, v52, v52, s12
    v_perm_b32 v84, v64, v64, s12
    v_perm_b32 v85, v64, v64, s12
    v_perm_b32 v86, v68, v64, v127
    v_perm_b32 v87, v68, v68, s12
    v_perm_b32 v88, v70, v70, s12
    v_perm_b32 v89, v70, v70, s12
    v_perm_b32 v90, v74, v70, v127
    v_perm_b32 v91, v74, v74, s12
    buffer_store_dwordx4 v[76:79], v63, s[72:75], 0 offen offset:0 sc1
    buffer_store_dwordx4 v[80:83], v63, s[72:75], 0 offen offset:1024 sc1
    buffer_store_dwordx4 v[84:87], v63, s[72:75], 0 offen offset:2048 sc1
    buffer_store_dwordx4 v[88:91], v63, s[72:75], 0 offen offset:3072 sc1
    s_endpgm
L_prep_exit:
    s_endpgm
.globl conv_kernel
.p2align 8
.type conv_kernel,@function
conv_kernel:
    s_cmp_ge_u32 s2, 240
    s_cbranch_scc1 L_conv_exit
    s_load_dwordx16 s[16:31], s[0:1], 0
    s_load_dwordx16 s[32:47], s[0:1], 64
    v_lshrrev_b32 v2, 6, v0
    v_and_b32 v1, 63, v0
    s_and_b32 s6, s2, 7
    v_readfirstlane_b32 s3, v2
    s_lshr_b32 s7, s2, 3
    s_mul_i32 s5, s6, 10
    s_cmp_lt_u32 s7, 10
    s_cbranch_scc1 L_T2
    s_sub_u32 s7, s7, 10
    s_cmp_ge_u32 s7, 10
    s_cselect_b32 s4, 1, 0
    s_mul_i32 s8, s4, 10
    s_sub_u32 s7, s7, s8
    s_add_u32 s5, s5, s7
    s_lshl_b32 s8, s5, 3
    s_add_u32 s8, s8, s3
    s_mul_i32 s9, s4, 640
    s_add_u32 s9, s9, s8
    s_lshl_b32 s10, s8, 12
    s_lshl_b32 s13, s9, 12
    s_mul_i32 s70, s3, 4608
    s_mul_i32 s71, s3, 8320
    s_add_u32 s71, s71, 36864
    v_lshlrev_b32 v13, 4, v1
    v_and_b32 v88, 15, v1
    v_lshrrev_b32 v89, 4, v1
    v_lshlrev_b32 v90, 5, v88
    v_lshlrev_b32 v91, 4, v89
    v_sub_u32 v90, v91, v90
    s_add_u32 s14, s70, 480
    v_add_u32 v4, s14, v90
    v_add_u32 v90, 1, v88
    v_and_b32 v91, 1, v90
    v_lshl_add_u32 v90, v89, 3, v90
    v_lshrrev_b32 v90, 1, v90
    v_lshlrev_b32 v90, 2, v90
    v_mul_u32_u24 v91, 4160, v91
    v_add_u32 v90, v90, v91
    v_add_u32 v5, s71, v90
    v_add_u32 v6, 1024, v5
    v_add_u32 v7, 2048, v5
    v_add_u32 v8, 3072, v5
    s_add_u32 s14, s70, 4096
    v_lshl_add_u32 v90, v1, 4, s14
    s_sub_u32 s14, s71, 480
    v_lshl_add_u32 v91, v1, 4, s14
    s_add_u32 s14, s71, 3648
    v_lshl_add_u32 v92, v1, 4, s14
    v_cmp_gt_u32 vcc, 32, v1
    v_mov_b32 v93, 66560
    v_mov_b32 v94, 36864
    v_cndmask_b32 v91, v92, v91, vcc
    v_cmp_gt_u32 vcc, 30, v1
    v_mov_b32 v80, 0
    v_mov_b32 v81, 0
    v_mov_b32 v82, 0
    v_mov_b32 v83, 0
    v_cndmask_b32 v90, v91, v90, vcc
    v_cndmask_b32 v93, v93, v94, vcc
    s_mov_b32 exec_hi, 3
    ds_write_b128 v90, v[80:83]
    s_mov_b64 exec, -1
    v_mov_b32 v14, s71
    s_mov_b32 s50, 5242880
    s_mov_b32 s51, 0x00020000
    s_mov_b32 s54, 2621440
    s_mov_b32 s55, 0x00020000
    s_waitcnt lgkmcnt(0)
    s_mov_b32 s48, s46
    s_and_b32 s49, s47, 0xffff
    s_add_u32 s6, s46, 5242880
    s_addc_u32 s7, s47, 0
    s_cmp_eq_u32 s4, 1
    s_cselect_b32 s6, s38, s6
    s_cselect_b32 s7, s39, s7
    s_mov_b32 s52, s6
    s_and_b32 s53, s7, 0xffff
    s_cmp_ge_u32 s3, 4
    s_cbranch_scc1 L_xdma_9
    s_add_u32 s15, s13, 0
    s_add_u32 m0, s70, 0
    s_nop 0
    buffer_load_dwordx4 v13, s[48:51], s15 offen offset:3072 lds
    s_add_u32 s15, s10, 0
    s_add_u32 m0, s71, 32
    s_nop 0
    buffer_load_dwordx4 v13, s[52:55], s15 offen offset:3072 lds
    s_add_u32 s15, s10, 2
    s_add_u32 m0, s71, 4192
    s_nop 0
    buffer_load_dwordx4 v13, s[52:55], s15 offen offset:3072 lds
L_xdma_9:
    s_mul_i32 s14, s3, 2624
    s_add_u32 s14, s14, 103424
    s_lshl_b32 s11, s5, 4
    v_mul_u32_u24 v90, 40, v88
    v_lshl_add_u32 v90, v89, 3, v90
    v_add_u32 v9, s14, v90
    s_and_b32 s12, s3, 3
    v_bfe_u32 v90, v1, 2, 2
    v_mul_u32_u24 v90, 2624, v90
    v_and_b32 v91, 3, v1
    v_lshl_add_u32 v90, v91, 3, v90
    v_mul_u32_u24 v91, 40, v89
    v_add_u32 v90, v90, v91
    s_mul_i32 s14, s12, 160
    s_add_u32 s14, s14, 103424
    v_add_u32 v10, s14, v90
    s_lshl_b32 s14, s12, 6
    v_add_u32 v90, s14, v1
    v_mul_u32_u24 v12, 1280, v90
    v_add_u32 v12, s11, v12
    v_mul_u32_u24 v11, 2560, v90
    s_mul_i32 s14, s4, 1280
    s_add_u32 s14, s14, s11
    v_add_u32 v11, s14, v11
    s_cmp_ge_u32 s3, 4
    s_cbranch_scc1 L_xdma2_10
    s_add_u32 s15, s10, 0
    s_add_u32 m0, s71, 32
    s_nop 0
    buffer_load_dwordx4 v13, s[52:55], s15 offen offset:2048 lds
    s_add_u32 s15, s10, 2
    s_add_u32 m0, s71, 4192
    s_nop 0
    buffer_load_dwordx4 v13, s[52:55], s15 offen offset:2048 lds
    s_add_u32 s15, s10, 0
    s_add_u32 m0, s71, 32
    s_nop 0
    buffer_load_dwordx4 v13, s[52:55], s15 offen offset:1024 lds
    s_add_u32 s15, s10, 2
    s_add_u32 m0, s71, 4192
    s_nop 0
    buffer_load_dwordx4 v13, s[52:55], s15 offen offset:1024 lds
L_xdma2_10:
    s_add_u32 s14, s10, 0
    s_load_dword s72, s[6:7], s14
    s_lshl_b32 s11, s8, 1
    s_and_b32 s11, s11, 0xfffffffc
    s_add_u32 s14, s11, 0
    s_load_dword s76, s[40:41], s14
    s_mov_b32 s56, s30
    s_and_b32 s57, s31, 0xffff
    s_mov_b32 s59, 0x00020000
    s_mov_b32 s60, s42
    s_and_b32 s61, s43, 0xffff
    s_mov_b32 s62, 5242880
    s_mov_b32 s63, 0x00020000
    s_cmp_eq_u32 s4, 1
    s_cselect_b32 s58, 2621440, 0
    s_cselect_b32 s69, 0, 0x3f800000
    s_cselect_b32 s67, 0, 0x3f80
    v_mov_b32 v86, 0xffff
    v_mov_b32 v87, 0xffff0000
    s_cmp_ge_u32 s3, 4
    s_cbranch_scc1 L_T1_Y
    s_waitcnt vmcnt(6)
    ds_read_b128 v[48:51], v4 offset:3584
    s_waitcnt vmcnt(4)
    ds_read2_b32 a[64:65], v8 offset0:128 offset1:129
    ds_read2_b32 a[66:67], v8 offset0:130 offset1:131
    ds_read_b128 v[52:55], v4 offset:3648
    ds_read2_b32 a[68:69], v8 offset0:144 offset1:145
    ds_read2_b32 a[70:71], v8 offset0:146 offset1:147
    ds_read_b128 v[56:59], v4 offset:3712
    s_waitcnt lgkmcnt(4)
    v_mfma_f32_16x16x32_bf16 v[28:31], a[64:67], v[48:51], 0
    s_barrier
    s_add_u32 s15, s13, 0
    s_add_u32 m0, s70, 0
    s_nop 0
    buffer_load_dwordx4 v13, s[48:51], s15 offen offset:2048 lds
    ds_read2_b32 a[72:73], v8 offset0:160 offset1:161
    ds_read2_b32 a[74:75], v8 offset0:162 offset1:163
    ds_read_b128 v[60:63], v4 offset:3776
    ds_read2_b32 a[76:77], v8 offset0:176 offset1:177
    ds_read2_b32 a[78:79], v8 offset0:178 offset1:179
    s_waitcnt lgkmcnt(6)
    v_mfma_f32_16x16x32_bf16 v[28:31], a[68:71], v[52:55], v[28:31]
    ds_read_b128 v[64:67], v4 offset:3840
    ds_read2_b32 a[80:81], v8 offset0:192 offset1:193
    ds_read2_b32 a[82:83], v8 offset0:194 offset1:195
    ds_read_b128 v[68:71], v4 offset:3904
    s_waitcnt lgkmcnt(7)
    v_mfma_f32_16x16x32_bf16 v[28:31], a[72:75], v[56:59], v[28:31]
    ds_read2_b32 a[84:85], v8 offset0:208 offset1:209
    ds_read2_b32 a[86:87], v8 offset0:210 offset1:211
    ds_read_b128 v[72:75], v4 offset:3968
    ds_read2_b32 a[88:89], v8 offset0:224 offset1:225
    ds_read2_b32 a[90:91], v8 offset0:226 offset1:227
    s_waitcnt lgkmcnt(9)
    v_mfma_f32_16x16x32_bf16 v[28:31], a[76:79], v[60:63], v[28:31]
    s_add_u32 s15, s10, 0
    s_add_u32 m0, s71, 32
    s_nop 0
    buffer_load_dwordx4 v13, s[52:55], s15 offen offset:0 lds
    ds_read_b128 v[76:79], v4 offset:4032
    ds_read2_b32 a[92:93], v8 offset0:240 offset1:241
    ds_read2_b32 a[94:95], v8 offset0:242 offset1:243
    s_waitcnt vmcnt(4)
    ds_read2_b32 a[32:33], v8 offset0:0 offset1:1
    ds_read2_b32 a[34:35], v8 offset0:2 offset1:3
    s_waitcnt lgkmcnt(11)
    v_mfma_f32_16x16x32_bf16 v[28:31], a[80:83], v[64:67], v[28:31]
    ds_read2_b32 a[36:37], v8 offset0:16 offset1:17
    ds_read2_b32 a[38:39], v8 offset0:18 offset1:19
    s_waitcnt lgkmcnt(10)
    v_mfma_f32_16x16x32_bf16 v[28:31], a[84:87], v[68:71], v[28:31]
    ds_read2_b32 a[40:41], v8 offset0:32 offset1:33
    ds_read2_b32 a[42:43], v8 offset0:34 offset1:35
    ds_read2_b32 a[44:45], v8 offset0:48 offset1:49
    ds_read2_b32 a[46:47], v8 offset0:50 offset1:51
    s_waitcnt lgkmcnt(11)
    v_mfma_f32_16x16x32_bf16 v[28:31], a[88:91], v[72:75], v[28:31]
    s_add_u32 s15, s10, 2
    s_add_u32 m0, s71, 4192
    s_nop 0
    buffer_load_dwordx4 v13, s[52:55], s15 offen offset:0 lds
    ds_read2_b32 a[48:49], v8 offset0:64 offset1:65
    ds_read2_b32 a[50:51], v8 offset0:66 offset1:67
    s_waitcnt lgkmcnt(10)
    v_mfma_f32_16x16x32_bf16 v[28:31], a[92:95], v[76:79], v[28:31]
    ds_read2_b32 a[52:53], v8 offset0:80 offset1:81
    ds_read2_b32 a[54:55], v8 offset0:82 offset1:83
    ds_read2_b32 a[56:57], v8 offset0:96 offset1:97
    ds_read2_b32 a[58:59], v8 offset0:98 offset1:99
    s_waitcnt lgkmcnt(12)
    v_mfma_f32_16x16x32_bf16 v[24:27], a[32:35], v[48:51], 0
    ds_read2_b32 a[60:61], v8 offset0:112 offset1:113
    ds_read2_b32 a[62:63], v8 offset0:114 offset1:115
    s_waitcnt lgkmcnt(12)
    v_mfma_f32_16x16x32_bf16 v[24:27], a[36:39], v[52:55], v[24:27]
    s_add_u32 s15, s13, 0
    s_add_u32 m0, s70, 0
    s_nop 0
    buffer_load_dwordx4 v13, s[48:51], s15 offen offset:1024 lds
    ds_read2_b32 a[0:1], v7 offset0:128 offset1:129
    ds_read2_b32 a[2:3], v7 offset0:130 offset1:131
    s_waitcnt lgkmcnt(12)
    v_mfma_f32_16x16x32_bf16 v[24:27], a[40:43], v[56:59], v[24:27]
    ds_read2_b32 a[4:5], v7 offset0:144 offset1:145
    ds_read2_b32 a[6:7], v7 offset0:146 offset1:147
    s_waitcnt lgkmcnt(12)
    v_mfma_f32_16x16x32_bf16 v[24:27], a[44:47], v[60:63], v[24:27]
    ds_read2_b32 a[8:9], v7 offset0:160 offset1:161
    ds_read2_b32 a[10:11], v7 offset0:162 offset1:163
    s_waitcnt lgkmcnt(12)
    v_mfma_f32_16x16x32_bf16 v[24:27], a[48:51], v[64:67], v[24:27]
    s_add_u32 s15, s13, 0
    s_add_u32 m0, s70, 0
    s_nop 0
    buffer_load_dwordx4 v13, s[48:51], s15 offen offset:0 lds
    ds_read2_b32 a[12:13], v7 offset0:176 offset1:177
    ds_read2_b32 a[14:15], v7 offset0:178 offset1:179
    s_waitcnt lgkmcnt(12)
    v_mfma_f32_16x16x32_bf16 v[24:27], a[52:55], v[68:71], v[24:27]
    ds_read2_b32 a[16:17], v7 offset0:192 offset1:193
    ds_read2_b32 a[18:19], v7 offset0:194 offset1:195
    s_waitcnt lgkmcnt(12)
    v_mfma_f32_16x16x32_bf16 v[24:27], a[56:59], v[72:75], v[24:27]
    ds_read2_b32 a[20:21], v7 offset0:208 offset1:209
    ds_read2_b32 a[22:23], v7 offset0:210 offset1:211
    s_waitcnt lgkmcnt(12)
    v_mfma_f32_16x16x32_bf16 v[24:27], a[60:63], v[76:79], v[24:27]
    ds_read2_b32 a[24:25], v7 offset0:224 offset1:225
    ds_read2_b32 a[26:27], v7 offset0:226 offset1:227
    s_waitcnt lgkmcnt(12)
    v_mfma_f32_16x16x32_bf16 v[20:23], a[0:3], v[48:51], 0
    ds_read2_b32 a[28:29], v7 offset0:240 offset1:241
    ds_read2_b32 a[30:31], v7 offset0:242 offset1:243
    s_waitcnt lgkmcnt(12)
    v_mfma_f32_16x16x32_bf16 v[20:23], a[4:7], v[52:55], v[20:23]
    s_waitcnt vmcnt(5)
    ds_read2_b32 a[128:129], v7 offset0:0 offset1:1
    ds_read2_b32 a[130:131], v7 offset0:2 offset1:3
    s_waitcnt lgkmcnt(12)
    v_mfma_f32_16x16x32_bf16 v[20:23], a[8:11], v[56:59], v[20:23]
    ds_read2_b32 a[132:133], v7 offset0:16 offset1:17
    ds_read2_b32 a[134:135], v7 offset0:18 offset1:19
    s_waitcnt lgkmcnt(12)
    v_mfma_f32_16x16x32_bf16 v[20:23], a[12:15], v[60:63], v[20:23]
    ds_read2_b32 a[136:137], v7 offset0:32 offset1:33
    ds_read2_b32 a[138:139], v7 offset0:34 offset1:35
    s_waitcnt lgkmcnt(12)
    v_mfma_f32_16x16x32_bf16 v[20:23], a[16:19], v[64:67], v[20:23]
    s_mov_b32 s14, 1310720
    buffer_load_dwordx4 v[32:35], v12, s[56:59], s14 offen
    ds_read2_b32 a[140:141], v7 offset0:48 offset1:49
    ds_read2_b32 a[142:143], v7 offset0:50 offset1:51
    s_waitcnt lgkmcnt(12)
    v_mfma_f32_16x16x32_bf16 v[20:23], a[20:23], v[68:71], v[20:23]
    ds_read2_b32 a[144:145], v7 offset0:64 offset1:65
    ds_read2_b32 a[146:147], v7 offset0:66 offset1:67
    s_waitcnt lgkmcnt(12)
    v_mfma_f32_16x16x32_bf16 v[20:23], a[24:27], v[72:75], v[20:23]
    ds_read2_b32 a[148:149], v7 offset0:80 offset1:81
    ds_read2_b32 a[150:151], v7 offset0:82 offset1:83
    s_waitcnt lgkmcnt(12)
    v_mfma_f32_16x16x32_bf16 v[20:23], a[28:31], v[76:79], v[20:23]
    ds_read2_b32 a[152:153], v7 offset0:96 offset1:97
    ds_read2_b32 a[154:155], v7 offset0:98 offset1:99
    s_waitcnt lgkmcnt(12)
    v_mfma_f32_16x16x32_bf16 v[16:19], a[128:131], v[48:51], 0
    ds_read2_b32 a[156:157], v7 offset0:112 offset1:113
    ds_read2_b32 a[158:159], v7 offset0:114 offset1:115
    s_waitcnt lgkmcnt(12)
    v_mfma_f32_16x16x32_bf16 v[16:19], a[132:135], v[52:55], v[16:19]
    ds_read_b128 v[48:51], v4 offset:3072
    ds_read_b128 v[52:55], v4 offset:3136
    s_waitcnt lgkmcnt(12)
    v_mfma_f32_16x16x32_bf16 v[16:19], a[136:139], v[56:59], v[16:19]
    s_mov_b32 s14, 1966080
    buffer_load_dwordx4 v[36:39], v12, s[56:59], s14 offen
    ds_read2_b32 a[96:97], v6 offset0:128 offset1:129
    ds_read2_b32 a[98:99], v6 offset0:130 offset1:131
    s_waitcnt lgkmcnt(12)
    v_mfma_f32_16x16x32_bf16 v[16:19], a[140:143], v[60:63], v[16:19]
    ds_read2_b32 a[100:101], v6 offset0:144 offset1:145
    ds_read2_b32 a[102:103], v6 offset0:146 offset1:147
    s_waitcnt lgkmcnt(12)
    v_mfma_f32_16x16x32_bf16 v[16:19], a[144:147], v[64:67], v[16:19]
    ds_read_b128 v[56:59], v4 offset:3200
    ds_read_b128 v[60:63], v4 offset:3264
    s_waitcnt lgkmcnt(12)
    v_mfma_f32_16x16x32_bf16 v[16:19], a[148:151], v[68:71], v[16:19]
    ds_read2_b32 a[104:105], v6 offset0:160 offset1:161
    ds_read2_b32 a[106:107], v6 offset0:162 offset1:163
    s_waitcnt lgkmcnt(12)
    v_mfma_f32_16x16x32_bf16 v[16:19], a[152:155], v[72:75], v[16:19]
    ds_read2_b32 a[108:109], v6 offset0:176 offset1:177
    ds_read2_b32 a[110:111], v6 offset0:178 offset1:179
    s_waitcnt lgkmcnt(12)
    v_mfma_f32_16x16x32_bf16 v[16:19], a[156:159], v[76:79], v[16:19]
    ds_read_b128 v[64:67], v4 offset:3328
    ds_read_b128 v[68:71], v4 offset:3392
    s_waitcnt lgkmcnt(13)
    v_mfma_f32_16x16x32_bf16 v[28:31], a[32:35], v[48:51], v[28:31]
    ds_read_b128 v[72:75], v4 offset:3456
    v_mfma_f32_16x16x32_bf16 v[24:27], a[0:3], v[48:51], v[24:27]
    v_mfma_f32_16x16x32_bf16 v[20:23], a[128:131], v[48:51], v[20:23]
    s_waitcnt lgkmcnt(11)
    v_mfma_f32_16x16x32_bf16 v[16:19], a[96:99], v[48:51], v[16:19]
    ds_read2_b32 a[112:113], v6 offset0:192 offset1:193
    ds_read2_b32 a[114:115], v6 offset0:194 offset1:195
    v_mfma_f32_16x16x32_bf16 v[28:31], a[36:39], v[52:55], v[28:31]
    ds_read_b128 v[76:79], v4 offset:3520
    v_mfma_f32_16x16x32_bf16 v[24:27], a[4:7], v[52:55], v[24:27]
    v_mfma_f32_16x16x32_bf16 v[20:23], a[132:135], v[52:55], v[20:23]
    s_waitcnt lgkmcnt(12)
    v_mfma_f32_16x16x32_bf16 v[16:19], a[100:103], v[52:55], v[16:19]
    ds_read2_b32 a[116:117], v6 offset0:208 offset1:209
    ds_read2_b32 a[118:119], v6 offset0:210 offset1:211
    s_waitcnt lgkmcnt(13)
    v_mfma_f32_16x16x32_bf16 v[28:31], a[40:43], v[56:59], v[28:31]
    s_waitcnt vmcnt(6)
    ds_read_b128 v[48:51], v4 offset:2560
    v_mfma_f32_16x16x32_bf16 v[24:27], a[8:11], v[56:59], v[24:27]
    v_mfma_f32_16x16x32_bf16 v[20:23], a[136:139], v[56:59], v[20:23]
    s_waitcnt lgkmcnt(11)
    v_mfma_f32_16x16x32_bf16 v[16:19], a[104:107], v[56:59], v[16:19]
    ds_read2_b32 a[120:121], v6 offset0:224 offset1:225
    ds_read2_b32 a[122:123], v6 offset0:226 offset1:227
    v_mfma_f32_16x16x32_bf16 v[28:31], a[44:47], v[60:63], v[28:31]
    ds_read_b128 v[52:55], v4 offset:2624
    v_mfma_f32_16x16x32_bf16 v[24:27], a[12:15], v[60:63], v[24:27]
    v_mfma_f32_16x16x32_bf16 v[20:23], a[140:143], v[60:63], v[20:23]
    s_waitcnt lgkmcnt(12)
    v_mfma_f32_16x16x32_bf16 v[16:19], a[108:111], v[60:63], v[16:19]
    ds_read2_b32 a[124:125], v6 offset0:240 offset1:241
    ds_read2_b32 a[126:127], v6 offset0:242 offset1:243
    s_waitcnt lgkmcnt(13)
    v_mfma_f32_16x16x32_bf16 v[28:31], a[48:51], v[64:67], v[28:31]
    ds_read_b128 v[56:59], v4 offset:2688
    v_mfma_f32_16x16x32_bf16 v[24:27], a[16:19], v[64:67], v[24:27]
    v_mfma_f32_16x16x32_bf16 v[20:23], a[144:147], v[64:67], v[20:23]
    s_waitcnt lgkmcnt(10)
    v_mfma_f32_16x16x32_bf16 v[16:19], a[112:115], v[64:67], v[16:19]
    s_waitcnt vmcnt(4)
    ds_read2_b32 a[64:65], v6 offset0:0 offset1:1
    ds_read2_b32 a[66:67], v6 offset0:2 offset1:3
    v_mfma_f32_16x16x32_bf16 v[28:31], a[52:55], v[68:71], v[28:31]
    ds_read2_b32 a[68:69], v6 offset0:16 offset1:17
    ds_read2_b32 a[70:71], v6 offset0:18 offset1:19
    v_mfma_f32_16x16x32_bf16 v[24:27], a[20:23], v[68:71], v[24:27]
    v_mfma_f32_16x16x32_bf16 v[20:23], a[148:151], v[68:71], v[20:23]
    s_waitcnt lgkmcnt(11)
    v_mfma_f32_16x16x32_bf16 v[16:19], a[116:119], v[68:71], v[16:19]
    ds_read2_b32 a[72:73], v6 offset0:32 offset1:33
    ds_read2_b32 a[74:75], v6 offset0:34 offset1:35
    v_mfma_f32_16x16x32_bf16 v[28:31], a[56:59], v[72:75], v[28:31]
    ds_read_b128 v[60:63], v4 offset:2752
    v_mfma_f32_16x16x32_bf16 v[24:27], a[24:27], v[72:75], v[24:27]
    v_mfma_f32_16x16x32_bf16 v[20:23], a[152:155], v[72:75], v[20:23]
    s_waitcnt lgkmcnt(11)
    v_mfma_f32_16x16x32_bf16 v[16:19], a[120:123], v[72:75], v[16:19]
    ds_read2_b32 a[76:77], v6 offset0:48 offset1:49
    ds_read2_b32 a[78:79], v6 offset0:50 offset1:51
    v_mfma_f32_16x16x32_bf16 v[28:31], a[60:63], v[76:79], v[28:31]
    ds_read_b128 v[64:67], v4 offset:2816
    v_mfma_f32_16x16x32_bf16 v[24:27], a[28:31], v[76:79], v[24:27]
    v_mfma_f32_16x16x32_bf16 v[20:23], a[156:159], v[76:79], v[20:23]
    s_waitcnt lgkmcnt(11)
    v_mfma_f32_16x16x32_bf16 v[16:19], a[124:127], v[76:79], v[16:19]
    ds_read2_b32 a[80:81], v6 offset0:64 offset1:65
    ds_read2_b32 a[82:83], v6 offset0:66 offset1:67
    v_mfma_f32_16x16x32_bf16 v[28:31], a[0:3], v[48:51], v[28:31]
    ds_read_b128 v[68:71], v4 offset:2880
    v_mfma_f32_16x16x32_bf16 v[24:27], a[128:131], v[48:51], v[24:27]
    v_mfma_f32_16x16x32_bf16 v[20:23], a[96:99], v[48:51], v[20:23]
    s_waitcnt lgkmcnt(11)
    v_mfma_f32_16x16x32_bf16 v[16:19], a[64:67], v[48:51], v[16:19]
    ds_read2_b32 a[84:85], v6 offset0:80 offset1:81
    ds_read2_b32 a[86:87], v6 offset0:82 offset1:83
    v_mfma_f32_16x16x32_bf16 v[28:31], a[4:7], v[52:55], v[28:31]
    ds_read_b128 v[72:75], v4 offset:2944
    v_mfma_f32_16x16x32_bf16 v[24:27], a[132:135], v[52:55], v[24:27]
    v_mfma_f32_16x16x32_bf16 v[20:23], a[100:103], v[52:55], v[20:23]
    s_waitcnt lgkmcnt(12)
    v_mfma_f32_16x16x32_bf16 v[16:19], a[68:71], v[52:55], v[16:19]
    ds_read2_b32 a[88:89], v6 offset0:96 offset1:97
    ds_read2_b32 a[90:91], v6 offset0:98 offset1:99
    v_mfma_f32_16x16x32_bf16 v[28:31], a[8:11], v[56:59], v[28:31]
    v_mfma_f32_16x16x32_bf16 v[24:27], a[136:139], v[56:59], v[24:27]
    v_mfma_f32_16x16x32_bf16 v[20:23], a[104:107], v[56:59], v[20:23]
    s_waitcnt lgkmcnt(12)
    v_mfma_f32_16x16x32_bf16 v[16:19], a[72:75], v[56:59], v[16:19]
    ds_read_b128 v[76:79], v4 offset:3008
    ds_read_b128 v[48:51], v4 offset:2048
    s_waitcnt lgkmcnt(13)
    v_mfma_f32_16x16x32_bf16 v[28:31], a[12:15], v[60:63], v[28:31]
    ds_read_b128 v[52:55], v4 offset:2112
    v_mfma_f32_16x16x32_bf16 v[24:27], a[140:143], v[60:63], v[24:27]
    v_mfma_f32_16x16x32_bf16 v[20:23], a[108:111], v[60:63], v[20:23]
    s_waitcnt lgkmcnt(12)
    v_mfma_f32_16x16x32_bf16 v[16:19], a[76:79], v[60:63], v[16:19]
    ds_read2_b32 a[92:93], v6 offset0:112 offset1:113
    ds_read2_b32 a[94:95], v6 offset0:114 offset1:115
    s_waitcnt lgkmcnt(13)
    v_mfma_f32_16x16x32_bf16 v[28:31], a[16:19], v[64:67], v[28:31]
    ds_read_b128 v[56:59], v4 offset:2176
    v_mfma_f32_16x16x32_bf16 v[24:27], a[144:147], v[64:67], v[24:27]
    v_mfma_f32_16x16x32_bf16 v[20:23], a[112:115], v[64:67], v[20:23]
    s_waitcnt lgkmcnt(12)
    v_mfma_f32_16x16x32_bf16 v[16:19], a[80:83], v[64:67], v[16:19]
    ds_read2_b32 a[32:33], v5 offset0:128 offset1:129
    ds_read2_b32 a[34:35], v5 offset0:130 offset1:131
    s_waitcnt lgkmcnt(13)
    v_mfma_f32_16x16x32_bf16 v[28:31], a[20:23], v[68:71], v[28:31]
    ds_read_b128 v[60:63], v4 offset:2240
    v_mfma_f32_16x16x32_bf16 v[24:27], a[148:151], v[68:71], v[24:27]
    v_mfma_f32_16x16x32_bf16 v[20:23], a[116:119], v[68:71], v[20:23]
    s_waitcnt lgkmcnt(12)
    v_mfma_f32_16x16x32_bf16 v[16:19], a[84:87], v[68:71], v[16:19]
    ds_read2_b32 a[36:37], v5 offset0:144 offset1:145
    ds_read2_b32 a[38:39], v5 offset0:146 offset1:147
    s_waitcnt lgkmcnt(13)
    v_mfma_f32_16x16x32_bf16 v[28:31], a[24:27], v[72:75], v[28:31]
    ds_read_b128 v[64:67], v4 offset:2304
    v_mfma_f32_16x16x32_bf16 v[24:27], a[152:155], v[72:75], v[24:27]
    v_mfma_f32_16x16x32_bf16 v[20:23], a[120:123], v[72:75], v[20:23]
    s_waitcnt lgkmcnt(12)
    v_mfma_f32_16x16x32_bf16 v[16:19], a[88:91], v[72:75], v[16:19]
    ds_read2_b32 a[40:41], v5 offset0:160 offset1:161
    ds_read2_b32 a[42:43], v5 offset0:162 offset1:163
    s_waitcnt lgkmcnt(13)
    v_mfma_f32_16x16x32_bf16 v[28:31], a[28:31], v[76:79], v[28:31]
    ds_read_b128 v[68:71], v4 offset:2368
    v_mfma_f32_16x16x32_bf16 v[24:27], a[156:159], v[76:79], v[24:27]
    v_mfma_f32_16x16x32_bf16 v[20:23], a[124:127], v[76:79], v[20:23]
    s_waitcnt lgkmcnt(10)
    v_mfma_f32_16x16x32_bf16 v[16:19], a[92:95], v[76:79], v[16:19]
    ds_read2_b32 a[44:45], v5 offset0:176 offset1:177
    ds_read2_b32 a[46:47], v5 offset0:178 offset1:179
    v_mfma_f32_16x16x32_bf16 v[28:31], a[128:131], v[48:51], v[28:31]
    ds_read2_b32 a[48:49], v5 offset0:192 offset1:193
    ds_read2_b32 a[50:51], v5 offset0:194 offset1:195
    v_mfma_f32_16x16x32_bf16 v[24:27], a[96:99], v[48:51], v[24:27]
    v_mfma_f32_16x16x32_bf16 v[20:23], a[64:67], v[48:51], v[20:23]
    s_waitcnt lgkmcnt(11)
    v_mfma_f32_16x16x32_bf16 v[16:19], a[32:35], v[48:51], v[16:19]
    ds_read2_b32 a[52:53], v5 offset0:208 offset1:209
    ds_read2_b32 a[54:55], v5 offset0:210 offset1:211
    v_mfma_f32_16x16x32_bf16 v[28:31], a[132:135], v[52:55], v[28:31]
    ds_read_b128 v[72:75], v4 offset:2432
    v_mfma_f32_16x16x32_bf16 v[24:27], a[100:103], v[52:55], v[24:27]
    v_mfma_f32_16x16x32_bf16 v[20:23], a[68:71], v[52:55], v[20:23]
    s_waitcnt lgkmcnt(11)
    v_mfma_f32_16x16x32_bf16 v[16:19], a[36:39], v[52:55], v[16:19]
    ds_read2_b32 a[56:57], v5 offset0:224 offset1:225
    ds_read2_b32 a[58:59], v5 offset0:226 offset1:227
    v_mfma_f32_16x16x32_bf16 v[28:31], a[136:139], v[56:59], v[28:31]
    ds_read_b128 v[76:79], v4 offset:2496
    v_mfma_f32_16x16x32_bf16 v[24:27], a[104:107], v[56:59], v[24:27]
    v_mfma_f32_16x16x32_bf16 v[20:23], a[72:75], v[56:59], v[20:23]
    s_waitcnt lgkmcnt(11)
    v_mfma_f32_16x16x32_bf16 v[16:19], a[40:43], v[56:59], v[16:19]
    ds_read2_b32 a[60:61], v5 offset0:240 offset1:241
    ds_read2_b32 a[62:63], v5 offset0:242 offset1:243
    v_mfma_f32_16x16x32_bf16 v[28:31], a[140:143], v[60:63], v[28:31]
    s_waitcnt vmcnt(3)
    ds_read_b128 v[48:51], v4 offset:1536
    v_mfma_f32_16x16x32_bf16 v[24:27], a[108:111], v[60:63], v[24:27]
    v_mfma_f32_16x16x32_bf16 v[20:23], a[76:79], v[60:63], v[20:23]
    s_waitcnt lgkmcnt(11)
    v_mfma_f32_16x16x32_bf16 v[16:19], a[44:47], v[60:63], v[16:19]
    s_waitcnt lgkmcnt(0)
    s_and_b32 s14, s8, 1
    s_lshl_b32 s14, s14, 4
    s_lshl_b32 s72, s72, 16
    s_lshr_b32 s76, s76, s14
    s_lshl_b32 s76, s76, 16
    s_cmp_eq_u32 s4, 1
    s_cselect_b32 s76, s76, 0
    v_mov_b32 v2, s72
    v_add_f32 v2, s76, v2
    v_cvt_pk_bf16_f32 v2, v2, v2
    ds_write_b16 v14, v2 offset:32
    ds_write_b16 v14, v2 offset:4190
    ds_read2_b32 a[0:1], v5 offset0:0 offset1:1
    ds_read2_b32 a[2:3], v5 offset0:2 offset1:3
    v_mfma_f32_16x16x32_bf16 v[28:31], a[144:147], v[64:67], v[28:31]
    ds_read_b128 v[52:55], v4 offset:1600
    ds_read2_b32 a[4:5], v5 offset0:16 offset1:17
    ds_read2_b32 a[6:7], v5 offset0:18 offset1:19
    v_mfma_f32_16x16x32_bf16 v[24:27], a[112:115], v[64:67], v[24:27]
    ds_read_b128 v[56:59], v4 offset:1664
    ds_read2_b32 a[8:9], v5 offset0:32 offset1:33
    ds_read2_b32 a[10:11], v5 offset0:34 offset1:35
    v_mfma_f32_16x16x32_bf16 v[20:23], a[80:83], v[64:67], v[20:23]
    ds_read_b128 v[60:63], v4 offset:1728
    ds_read2_b32 a[12:13], v5 offset0:48 offset1:49
    ds_read2_b32 a[14:15], v5 offset0:50 offset1:51
    v_mfma_f32_16x16x32_bf16 v[16:19], a[48:51], v[64:67], v[16:19]
    ds_read_b128 v[64:67], v4 offset:1792
    v_mfma_f32_16x16x32_bf16 v[28:31], a[148:151], v[68:71], v[28:31]
    v_mfma_f32_16x16x32_bf16 v[24:27], a[116:119], v[68:71], v[24:27]
    v_mfma_f32_16x16x32_bf16 v[20:23], a[84:87], v[68:71], v[20:23]
    v_mfma_f32_16x16x32_bf16 v[16:19], a[52:55], v[68:71], v[16:19]
    v_mfma_f32_16x16x32_bf16 v[28:31], a[152:155], v[72:75], v[28:31]
    v_mfma_f32_16x16x32_bf16 v[24:27], a[120:123], v[72:75], v[24:27]
    v_mfma_f32_16x16x32_bf16 v[20:23], a[88:91], v[72:75], v[20:23]
    v_mfma_f32_16x16x32_bf16 v[16:19], a[56:59], v[72:75], v[16:19]
    v_mfma_f32_16x16x32_bf16 v[28:31], a[156:159], v[76:79], v[28:31]
    v_mfma_f32_16x16x32_bf16 v[24:27], a[124:127], v[76:79], v[24:27]
    v_mfma_f32_16x16x32_bf16 v[20:23], a[92:95], v[76:79], v[20:23]
    v_mfma_f32_16x16x32_bf16 v[16:19], a[60:63], v[76:79], v[16:19]
    v_mfma_f32_16x16x32_bf16 v[28:31], a[96:99], v[48:51], v[28:31]
    v_mfma_f32_16x16x32_bf16 v[24:27], a[64:67], v[48:51], v[24:27]
    v_mfma_f32_16x16x32_bf16 v[20:23], a[32:35], v[48:51], v[20:23]
    s_waitcnt lgkmcnt(10)
    v_mfma_f32_16x16x32_bf16 v[16:19], a[0:3], v[48:51], v[16:19]
    ds_read2_b32 a[16:17], v5 offset0:64 offset1:65
    ds_read2_b32 a[18:19], v5 offset0:66 offset1:67
    s_waitcnt lgkmcnt(11)
    v_mfma_f32_16x16x32_bf16 v[28:31], a[100:103], v[52:55], v[28:31]
    ds_read_b128 v[68:71], v4 offset:1856
    ds_read2_b32 a[20:21], v5 offset0:80 offset1:81
    ds_read2_b32 a[22:23], v5 offset0:82 offset1:83
    v_mfma_f32_16x16x32_bf16 v[24:27], a[68:71], v[52:55], v[24:27]
    v_mfma_f32_16x16x32_bf16 v[20:23], a[36:39], v[52:55], v[20:23]
    s_waitcnt lgkmcnt(12)
    v_mfma_f32_16x16x32_bf16 v[16:19], a[4:7], v[52:55], v[16:19]
    ds_read_b128 v[72:75], v4 offset:1920
    ds_read_b128 v[76:79], v4 offset:1984
    s_waitcnt lgkmcnt(13)
    v_mfma_f32_16x16x32_bf16 v[28:31], a[104:107], v[56:59], v[28:31]
    ds_read_b128 v[48:51], v4 offset:1024
    v_mfma_f32_16x16x32_bf16 v[24:27], a[72:75], v[56:59], v[24:27]
    v_mfma_f32_16x16x32_bf16 v[20:23], a[40:43], v[56:59], v[20:23]
    s_waitcnt lgkmcnt(12)
    v_mfma_f32_16x16x32_bf16 v[16:19], a[8:11], v[56:59], v[16:19]
    ds_read2_b32 a[24:25], v5 offset0:96 offset1:97
    ds_read2_b32 a[26:27], v5 offset0:98 offset1:99
    s_waitcnt lgkmcnt(13)
    v_mfma_f32_16x16x32_bf16 v[28:31], a[108:111], v[60:63], v[28:31]
    ds_read_b128 v[52:55], v4 offset:1088
    v_mfma_f32_16x16x32_bf16 v[24:27], a[76:79], v[60:63], v[24:27]
    v_mfma_f32_16x16x32_bf16 v[20:23], a[44:47], v[60:63], v[20:23]
    s_waitcnt lgkmcnt(12)
    v_mfma_f32_16x16x32_bf16 v[16:19], a[12:15], v[60:63], v[16:19]
    ds_read2_b32 a[28:29], v5 offset0:112 offset1:113
    ds_read2_b32 a[30:31], v5 offset0:114 offset1:115
    s_waitcnt lgkmcnt(13)
    v_mfma_f32_16x16x32_bf16 v[28:31], a[112:115], v[64:67], v[28:31]
    ds_read_b128 v[56:59], v4 offset:1152
    v_mfma_f32_16x16x32_bf16 v[24:27], a[80:83], v[64:67], v[24:27]
    v_mfma_f32_16x16x32_bf16 v[20:23], a[48:51], v[64:67], v[20:23]
    s_waitcnt lgkmcnt(12)
    v_mfma_f32_16x16x32_bf16 v[16:19], a[16:19], v[64:67], v[16:19]
    ds_read_b128 v[60:63], v4 offset:1216
    ds_read_b128 v[64:67], v4 offset:1280
    s_waitcnt lgkmcnt(13)
    v_mfma_f32_16x16x32_bf16 v[28:31], a[116:119], v[68:71], v[28:31]
    v_mfma_f32_16x16x32_bf16 v[24:27], a[84:87], v[68:71], v[24:27]
    v_mfma_f32_16x16x32_bf16 v[20:23], a[52:55], v[68:71], v[20:23]
    s_waitcnt lgkmcnt(11)
    v_mfma_f32_16x16x32_bf16 v[16:19], a[20:23], v[68:71], v[16:19]
    ds_read_b128 v[68:71], v4 offset:1344
    s_waitcnt lgkmcnt(11)
    v_mfma_f32_16x16x32_bf16 v[28:31], a[120:123], v[72:75], v[28:31]
    v_mfma_f32_16x16x32_bf16 v[24:27], a[88:91], v[72:75], v[24:27]
    v_mfma_f32_16x16x32_bf16 v[20:23], a[56:59], v[72:75], v[20:23]
    s_waitcnt lgkmcnt(7)
    v_mfma_f32_16x16x32_bf16 v[16:19], a[24:27], v[72:75], v[16:19]
    ds_read_b128 v[72:75], v4 offset:1408
    v_mfma_f32_16x16x32_bf16 v[28:31], a[124:127], v[76:79], v[28:31]
    v_mfma_f32_16x16x32_bf16 v[24:27], a[92:95], v[76:79], v[24:27]
    v_mfma_f32_16x16x32_bf16 v[20:23], a[60:63], v[76:79], v[20:23]
    s_waitcnt lgkmcnt(5)
    v_mfma_f32_16x16x32_bf16 v[16:19], a[28:31], v[76:79], v[16:19]
    ds_read_b128 v[76:79], v4 offset:1472
    v_mfma_f32_16x16x32_bf16 v[28:31], a[64:67], v[48:51], v[28:31]
    v_mfma_f32_16x16x32_bf16 v[24:27], a[32:35], v[48:51], v[24:27]
    v_mfma_f32_16x16x32_bf16 v[20:23], a[0:3], v[48:51], v[20:23]
    s_waitcnt vmcnt(2)
    ds_read_b128 v[48:51], v4 offset:512
    v_mfma_f32_16x16x32_bf16 v[28:31], a[68:71], v[52:55], v[28:31]
    s_nop 0
    v_cvt_pk_bf16_f32 v84, v16, v17
    v_cvt_pk_bf16_f32 v85, v18, v19
    ds_write_b64 v9, v[84:85] offset:0
    v_mfma_f32_16x16x32_bf16 v[24:27], a[36:39], v[52:55], v[24:27]
    v_mfma_f32_16x16x32_bf16 v[20:23], a[4:7], v[52:55], v[20:23]
    ds_read_b128 v[52:55], v4 offset:576
    s_waitcnt lgkmcnt(8)
    v_mfma_f32_16x16x32_bf16 v[28:31], a[72:75], v[56:59], v[28:31]
    v_mfma_f32_16x16x32_bf16 v[24:27], a[40:43], v[56:59], v[24:27]
    v_mfma_f32_16x16x32_bf16 v[20:23], a[8:11], v[56:59], v[20:23]
    s_waitcnt lgkmcnt(1)
    s_barrier
    ds_read_b64_tr_b16 v[88:89], v10 offset:0
    ds_read_b64_tr_b16 v[90:91], v10 offset:10496
    ds_read_b128 v[56:59], v4 offset:640
    v_mfma_f32_16x16x32_bf16 v[28:31], a[76:79], v[60:63], v[28:31]
    v_mfma_f32_16x16x32_bf16 v[24:27], a[44:47], v[60:63], v[24:27]
    v_mfma_f32_16x16x32_bf16 v[20:23], a[12:15], v[60:63], v[20:23]
    ds_read_b128 v[60:63], v4 offset:704
    v_mfma_f32_16x16x32_bf16 v[28:31], a[80:83], v[64:67], v[28:31]
    s_waitcnt vmcnt(1)
    s_waitcnt lgkmcnt(2)
    v_and_or_b32 v92, v32, v86, s67
    v_and_or_b32 v93, v32, v87, s69
    v_mfma_f32_16x16x32_bf16 v[24:27], a[48:51], v[64:67], v[24:27]
    v_and_or_b32 v94, v33, v86, s67
    v_and_or_b32 v95, v33, v87, s69
    v_dot2_f32_bf16 v92, v88, v92, 0
    v_mfma_f32_16x16x32_bf16 v[20:23], a[16:19], v[64:67], v[20:23]
    ds_read_b128 v[64:67], v4 offset:768
    v_dot2_f32_bf16 v93, v88, v93, 0
    v_dot2_f32_bf16 v94, v89, v94, 0
    v_dot2_f32_bf16 v95, v89, v95, 0
    v_mfma_f32_16x16x32_bf16 v[28:31], a[84:87], v[68:71], v[28:31]
    s_nop 1
    v_cvt_pk_bf16_f32 v88, v92, v93
    v_cvt_pk_bf16_f32 v89, v94, v95
    v_mfma_f32_16x16x32_bf16 v[24:27], a[52:55], v[68:71], v[24:27]
    v_and_or_b32 v92, v34, v86, s67
    v_and_or_b32 v93, v34, v87, s69
    v_and_or_b32 v94, v35, v86, s67
    v_mfma_f32_16x16x32_bf16 v[20:23], a[20:23], v[68:71], v[20:23]
    ds_read_b128 v[68:71], v4 offset:832
    v_and_or_b32 v95, v35, v87, s69
    v_dot2_f32_bf16 v92, v90, v92, 0
    v_dot2_f32_bf16 v93, v90, v93, 0
    v_mfma_f32_16x16x32_bf16 v[28:31], a[88:91], v[72:75], v[28:31]
    v_dot2_f32_bf16 v94, v91, v94, 0
    v_dot2_f32_bf16 v95, v91, v95, 0
    s_nop 1
    v_mfma_f32_16x16x32_bf16 v[24:27], a[56:59], v[72:75], v[24:27]
    v_cvt_pk_bf16_f32 v90, v92, v93
    v_cvt_pk_bf16_f32 v91, v94, v95
    s_mov_b32 s68, 2621440
    buffer_store_dwordx4 v[88:91], v11, s[60:63], s68 offen
    v_mfma_f32_16x16x32_bf16 v[20:23], a[24:27], v[72:75], v[20:23]
    ds_read_b128 v[72:75], v4 offset:896
    v_mfma_f32_16x16x32_bf16 v[28:31], a[92:95], v[76:79], v[28:31]
    v_mfma_f32_16x16x32_bf16 v[24:27], a[60:63], v[76:79], v[24:27]
    v_mfma_f32_16x16x32_bf16 v[20:23], a[28:31], v[76:79], v[20:23]
    ds_read_b128 v[76:79], v4 offset:960
    v_mfma_f32_16x16x32_bf16 v[28:31], a[32:35], v[48:51], v[28:31]
    v_mfma_f32_16x16x32_bf16 v[24:27], a[0:3], v[48:51], v[24:27]
    ds_read_b128 v[48:51], v4 offset:0
    v_mfma_f32_16x16x32_bf16 v[28:31], a[36:39], v[52:55], v[28:31]
    v_mfma_f32_16x16x32_bf16 v[24:27], a[4:7], v[52:55], v[24:27]
    s_nop 1
    v_cvt_pk_bf16_f32 v84, v20, v21
    v_cvt_pk_bf16_f32 v85, v22, v23
    ds_write_b64 v9, v[84:85] offset:640
    ds_read_b128 v[52:55], v4 offset:64
    s_waitcnt lgkmcnt(8)
    v_mfma_f32_16x16x32_bf16 v[28:31], a[40:43], v[56:59], v[28:31]
    v_mfma_f32_16x16x32_bf16 v[24:27], a[8:11], v[56:59], v[24:27]
    ds_read_b128 v[56:59], v4 offset:128
    s_waitcnt lgkmcnt(8)
    v_mfma_f32_16x16x32_bf16 v[28:31], a[44:47], v[60:63], v[28:31]
    v_mfma_f32_16x16x32_bf16 v[24:27], a[12:15], v[60:63], v[24:27]
    ds_read_b128 v[60:63], v4 offset:192
    s_waitcnt lgkmcnt(8)
    v_mfma_f32_16x16x32_bf16 v[28:31], a[48:51], v[64:67], v[28:31]
    s_waitcnt lgkmcnt(3)
    s_barrier
    v_mfma_f32_16x16x32_bf16 v[24:27], a[16:19], v[64:67], v[24:27]
    ds_read_b128 v[64:67], v4 offset:256
    v_mfma_f32_16x16x32_bf16 v[28:31], a[52:55], v[68:71], v[28:31]
    v_mfma_f32_16x16x32_bf16 v[24:27], a[20:23], v[68:71], v[24:27]
    ds_read_b128 v[68:71], v4 offset:320
    v_mfma_f32_16x16x32_bf16 v[28:31], a[56:59], v[72:75], v[28:31]
    v_mfma_f32_16x16x32_bf16 v[24:27], a[24:27], v[72:75], v[24:27]
    ds_read_b128 v[72:75], v4 offset:384
    v_mfma_f32_16x16x32_bf16 v[28:31], a[60:63], v[76:79], v[28:31]
    v_mfma_f32_16x16x32_bf16 v[24:27], a[28:31], v[76:79], v[24:27]
    ds_read_b128 v[76:79], v4 offset:448
    v_mfma_f32_16x16x32_bf16 v[28:31], a[0:3], v[48:51], v[28:31]
    s_waitcnt lgkmcnt(6)
    v_mfma_f32_16x16x32_bf16 v[28:31], a[4:7], v[52:55], v[28:31]
    s_waitcnt lgkmcnt(5)
    v_mfma_f32_16x16x32_bf16 v[28:31], a[8:11], v[56:59], v[28:31]
    s_waitcnt lgkmcnt(4)
    v_mfma_f32_16x16x32_bf16 v[28:31], a[12:15], v[60:63], v[28:31]
    v_cvt_pk_bf16_f32 v84, v24, v25
    v_cvt_pk_bf16_f32 v85, v26, v27
    ds_write_b64 v9, v[84:85] offset:1280
    s_waitcnt lgkmcnt(4)
    v_mfma_f32_16x16x32_bf16 v[28:31], a[16:19], v[64:67], v[28:31]
    s_waitcnt lgkmcnt(3)
    v_mfma_f32_16x16x32_bf16 v[28:31], a[20:23], v[68:71], v[28:31]
    s_waitcnt lgkmcnt(2)
    v_mfma_f32_16x16x32_bf16 v[28:31], a[24:27], v[72:75], v[28:31]
    s_waitcnt lgkmcnt(1)
    v_mfma_f32_16x16x32_bf16 v[28:31], a[28:31], v[76:79], v[28:31]
    s_nop 7
    v_cvt_pk_bf16_f32 v84, v28, v29
    v_cvt_pk_bf16_f32 v85, v30, v31
    ds_write_b64 v9, v[84:85] offset:1920
    s_waitcnt lgkmcnt(1)
    s_barrier
    ds_read_b64_tr_b16 v[88:89], v10 offset:1280
    ds_read_b64_tr_b16 v[90:91], v10 offset:11776
    s_waitcnt vmcnt(1)
    s_waitcnt lgkmcnt(0)
    v_and_or_b32 v92, v36, v86, s67
    v_and_or_b32 v93, v36, v87, s69
    v_and_or_b32 v94, v37, v86, s67
    v_and_or_b32 v95, v37, v87, s69
    v_dot2_f32_bf16 v92, v88, v92, 0
    v_dot2_f32_bf16 v93, v88, v93, 0
    v_dot2_f32_bf16 v94, v89, v94, 0
    v_dot2_f32_bf16 v95, v89, v95, 0
    s_nop 1
    v_cvt_pk_bf16_f32 v88, v92, v93
    v_cvt_pk_bf16_f32 v89, v94, v95
    v_and_or_b32 v92, v38, v86, s67
    v_and_or_b32 v93, v38, v87, s69
    v_and_or_b32 v94, v39, v86, s67
    v_and_or_b32 v95, v39, v87, s69
    v_dot2_f32_bf16 v92, v90, v92, 0
    v_dot2_f32_bf16 v93, v90, v93, 0
    v_dot2_f32_bf16 v94, v91, v94, 0
    v_dot2_f32_bf16 v95, v91, v95, 0
    s_nop 1
    v_cvt_pk_bf16_f32 v90, v92, v93
    v_cvt_pk_bf16_f32 v91, v94, v95
    s_mov_b32 s68, 3932160
    buffer_store_dwordx4 v[88:91], v11, s[60:63], s68 offen
    s_barrier
    s_endpgm
L_T1_Y:
    s_barrier
    s_add_u32 s15, s13, 0
    s_add_u32 m0, s70, 0
    s_nop 0
    buffer_load_dwordx4 v13, s[48:51], s15 offen offset:3072 lds
    s_add_u32 s15, s10, 0
    s_add_u32 m0, s71, 32
    s_nop 0
    buffer_load_dwordx4 v13, s[52:55], s15 offen offset:3072 lds
    s_add_u32 s15, s10, 2
    s_add_u32 m0, s71, 4192
    s_nop 0
    buffer_load_dwordx4 v13, s[52:55], s15 offen offset:3072 lds
    s_add_u32 s15, s10, 0
    s_add_u32 m0, s71, 32
    s_nop 0
    buffer_load_dwordx4 v13, s[52:55], s15 offen offset:2048 lds
    s_add_u32 s15, s10, 2
    s_add_u32 m0, s71, 4192
    s_nop 0
    buffer_load_dwordx4 v13, s[52:55], s15 offen offset:2048 lds
    s_add_u32 s15, s10, 0
    s_add_u32 m0, s71, 32
    s_nop 0
    buffer_load_dwordx4 v13, s[52:55], s15 offen offset:1024 lds
    s_add_u32 s15, s10, 2
    s_add_u32 m0, s71, 4192
    s_nop 0
    buffer_load_dwordx4 v13, s[52:55], s15 offen offset:1024 lds
    s_cmp_lg_u32 s3, 7
    s_cbranch_scc1 L_nocp_11
    s_getpc_b64 s[82:83]
L_pc_12:
    v_lshlrev_b32 v94, 7, v1
    v_min_u32 v94, L_end_T1-L_pc_12-4, v94
    global_load_dword v95, v94, s[82:83]
L_nocp_11:
    s_waitcnt vmcnt(6)
    ds_read_b128 v[48:51], v4 offset:3584
    s_waitcnt vmcnt(4)
    ds_read2_b32 a[64:65], v8 offset0:128 offset1:129
    ds_read2_b32 a[66:67], v8 offset0:130 offset1:131
    ds_read_b128 v[52:55], v4 offset:3648
    ds_read2_b32 a[68:69], v8 offset0:144 offset1:145
    ds_read2_b32 a[70:71], v8 offset0:146 offset1:147
    ds_read_b128 v[56:59], v4 offset:3712
    s_waitcnt lgkmcnt(4)
    v_mfma_f32_16x16x32_bf16 v[28:31], a[64:67], v[48:51], 0
    s_add_u32 s15, s13, 0
    s_add_u32 m0, s70, 0
    s_nop 0
    buffer_load_dwordx4 v13, s[48:51], s15 offen offset:2048 lds
    ds_read2_b32 a[72:73], v8 offset0:160 offset1:161
    ds_read2_b32 a[74:75], v8 offset0:162 offset1:163
    ds_read_b128 v[60:63], v4 offset:3776
    ds_read2_b32 a[76:77], v8 offset0:176 offset1:177
    ds_read2_b32 a[78:79], v8 offset0:178 offset1:179
    s_waitcnt lgkmcnt(6)
    v_mfma_f32_16x16x32_bf16 v[28:31], a[68:71], v[52:55], v[28:31]
    ds_read_b128 v[64:67], v4 offset:3840
    ds_read2_b32 a[80:81], v8 offset0:192 offset1:193
    ds_read2_b32 a[82:83], v8 offset0:194 offset1:195
    ds_read_b128 v[68:71], v4 offset:3904
    s_waitcnt lgkmcnt(7)
    v_mfma_f32_16x16x32_bf16 v[28:31], a[72:75], v[56:59], v[28:31]
    ds_read2_b32 a[84:85], v8 offset0:208 offset1:209
    ds_read2_b32 a[86:87], v8 offset0:210 offset1:211
    ds_read_b128 v[72:75], v4 offset:3968
    ds_read2_b32 a[88:89], v8 offset0:224 offset1:225
    ds_read2_b32 a[90:91], v8 offset0:226 offset1:227
    s_waitcnt lgkmcnt(9)
    v_mfma_f32_16x16x32_bf16 v[28:31], a[76:79], v[60:63], v[28:31]
    s_add_u32 s15, s10, 0
    s_add_u32 m0, s71, 32
    s_nop 0
    buffer_load_dwordx4 v13, s[52:55], s15 offen offset:0 lds
    ds_read_b128 v[76:79], v4 offset:4032
    ds_read2_b32 a[92:93], v8 offset0:240 offset1:241
    ds_read2_b32 a[94:95], v8 offset0:242 offset1:243
    s_waitcnt vmcnt(4)
    ds_read2_b32 a[32:33], v8 offset0:0 offset1:1
    ds_read2_b32 a[34:35], v8 offset0:2 offset1:3
    s_waitcnt lgkmcnt(11)
    v_mfma_f32_16x16x32_bf16 v[28:31], a[80:83], v[64:67], v[28:31]
    ds_read2_b32 a[36:37], v8 offset0:16 offset1:17
    ds_read2_b32 a[38:39], v8 offset0:18 offset1:19
    s_waitcnt lgkmcnt(10)
    v_mfma_f32_16x16x32_bf16 v[28:31], a[84:87], v[68:71], v[28:31]
    ds_read2_b32 a[40:41], v8 offset0:32 offset1:33
    ds_read2_b32 a[42:43], v8 offset0:34 offset1:35
    ds_read2_b32 a[44:45], v8 offset0:48 offset1:49
    ds_read2_b32 a[46:47], v8 offset0:50 offset1:51
    s_waitcnt lgkmcnt(11)
    v_mfma_f32_16x16x32_bf16 v[28:31], a[88:91], v[72:75], v[28:31]
    s_add_u32 s15, s10, 2
    s_add_u32 m0, s71, 4192
    s_nop 0
    buffer_load_dwordx4 v13, s[52:55], s15 offen offset:0 lds
    ds_read2_b32 a[48:49], v8 offset0:64 offset1:65
    ds_read2_b32 a[50:51], v8 offset0:66 offset1:67
    s_waitcnt lgkmcnt(10)
    v_mfma_f32_16x16x32_bf16 v[28:31], a[92:95], v[76:79], v[28:31]
    ds_read2_b32 a[52:53], v8 offset0:80 offset1:81
    ds_read2_b32 a[54:55], v8 offset0:82 offset1:83
    ds_read2_b32 a[56:57], v8 offset0:96 offset1:97
    ds_read2_b32 a[58:59], v8 offset0:98 offset1:99
    s_waitcnt lgkmcnt(12)
    v_mfma_f32_16x16x32_bf16 v[24:27], a[32:35], v[48:51], 0
    ds_read2_b32 a[60:61], v8 offset0:112 offset1:113
    ds_read2_b32 a[62:63], v8 offset0:114 offset1:115
    s_waitcnt lgkmcnt(12)
    v_mfma_f32_16x16x32_bf16 v[24:27], a[36:39], v[52:55], v[24:27]
    s_add_u32 s15, s13, 0
    s_add_u32 m0, s70, 0
    s_nop 0
    buffer_load_dwordx4 v13, s[48:51], s15 offen offset:1024 lds
    ds_read2_b32 a[0:1], v7 offset0:128 offset1:129
    ds_read2_b32 a[2:3], v7 offset0:130 offset1:131
    s_waitcnt lgkmcnt(12)
    v_mfma_f32_16x16x32_bf16 v[24:27], a[40:43], v[56:59], v[24:27]
    ds_read2_b32 a[4:5], v7 offset0:144 offset1:145
    ds_read2_b32 a[6:7], v7 offset0:146 offset1:147
    s_waitcnt lgkmcnt(12)
    v_mfma_f32_16x16x32_bf16 v[24:27], a[44:47], v[60:63], v[24:27]
    ds_read2_b32 a[8:9], v7 offset0:160 offset1:161
    ds_read2_b32 a[10:11], v7 offset0:162 offset1:163
    s_waitcnt lgkmcnt(12)
    v_mfma_f32_16x16x32_bf16 v[24:27], a[48:51], v[64:67], v[24:27]
    s_add_u32 s15, s13, 0
    s_add_u32 m0, s70, 0
    s_nop 0
    buffer_load_dwordx4 v13, s[48:51], s15 offen offset:0 lds
    ds_read2_b32 a[12:13], v7 offset0:176 offset1:177
    ds_read2_b32 a[14:15], v7 offset0:178 offset1:179
    s_waitcnt lgkmcnt(12)
    v_mfma_f32_16x16x32_bf16 v[24:27], a[52:55], v[68:71], v[24:27]
    ds_read2_b32 a[16:17], v7 offset0:192 offset1:193
    ds_read2_b32 a[18:19], v7 offset0:194 offset1:195
    s_waitcnt lgkmcnt(12)
    v_mfma_f32_16x16x32_bf16 v[24:27], a[56:59], v[72:75], v[24:27]
    ds_read2_b32 a[20:21], v7 offset0:208 offset1:209
    ds_read2_b32 a[22:23], v7 offset0:210 offset1:211
    s_waitcnt lgkmcnt(12)
    v_mfma_f32_16x16x32_bf16 v[24:27], a[60:63], v[76:79], v[24:27]
    ds_read2_b32 a[24:25], v7 offset0:224 offset1:225
    ds_read2_b32 a[26:27], v7 offset0:226 offset1:227
    s_waitcnt lgkmcnt(12)
    v_mfma_f32_16x16x32_bf16 v[20:23], a[0:3], v[48:51], 0
    ds_read2_b32 a[28:29], v7 offset0:240 offset1:241
    ds_read2_b32 a[30:31], v7 offset0:242 offset1:243
    s_waitcnt lgkmcnt(12)
    v_mfma_f32_16x16x32_bf16 v[20:23], a[4:7], v[52:55], v[20:23]
    s_waitcnt vmcnt(5)
    ds_read2_b32 a[128:129], v7 offset0:0 offset1:1
    ds_read2_b32 a[130:131], v7 offset0:2 offset1:3
    s_waitcnt lgkmcnt(12)
    v_mfma_f32_16x16x32_bf16 v[20:23], a[8:11], v[56:59], v[20:23]
    ds_read2_b32 a[132:133], v7 offset0:16 offset1:17
    ds_read2_b32 a[134:135], v7 offset0:18 offset1:19
    s_waitcnt lgkmcnt(12)
    v_mfma_f32_16x16x32_bf16 v[20:23], a[12:15], v[60:63], v[20:23]
    ds_read2_b32 a[136:137], v7 offset0:32 offset1:33
    ds_read2_b32 a[138:139], v7 offset0:34 offset1:35
    s_waitcnt lgkmcnt(12)
    v_mfma_f32_16x16x32_bf16 v[20:23], a[16:19], v[64:67], v[20:23]
    s_mov_b32 s14, 1638400
    buffer_load_dwordx4 v[32:35], v12, s[56:59], s14 offen
    ds_read2_b32 a[140:141], v7 offset0:48 offset1:49
    ds_read2_b32 a[142:143], v7 offset0:50 offset1:51
    s_waitcnt lgkmcnt(12)
    v_mfma_f32_16x16x32_bf16 v[20:23], a[20:23], v[68:71], v[20:23]
    ds_read2_b32 a[144:145], v7 offset0:64 offset1:65
    ds_read2_b32 a[146:147], v7 offset0:66 offset1:67
    s_waitcnt lgkmcnt(12)
    v_mfma_f32_16x16x32_bf16 v[20:23], a[24:27], v[72:75], v[20:23]
    ds_read2_b32 a[148:149], v7 offset0:80 offset1:81
    ds_read2_b32 a[150:151], v7 offset0:82 offset1:83
    s_waitcnt lgkmcnt(12)
    v_mfma_f32_16x16x32_bf16 v[20:23], a[28:31], v[76:79], v[20:23]
    ds_read2_b32 a[152:153], v7 offset0:96 offset1:97
    ds_read2_b32 a[154:155], v7 offset0:98 offset1:99
    s_waitcnt lgkmcnt(12)
    v_mfma_f32_16x16x32_bf16 v[16:19], a[128:131], v[48:51], 0
    ds_read2_b32 a[156:157], v7 offset0:112 offset1:113
    ds_read2_b32 a[158:159], v7 offset0:114 offset1:115
    s_waitcnt lgkmcnt(12)
    v_mfma_f32_16x16x32_bf16 v[16:19], a[132:135], v[52:55], v[16:19]
    ds_read_b128 v[48:51], v4 offset:3072
    ds_read_b128 v[52:55], v4 offset:3136
    s_waitcnt lgkmcnt(12)
    v_mfma_f32_16x16x32_bf16 v[16:19], a[136:139], v[56:59], v[16:19]
    s_mov_b32 s14, 2293760
    buffer_load_dwordx4 v[36:39], v12, s[56:59], s14 offen
    ds_read2_b32 a[96:97], v6 offset0:128 offset1:129
    ds_read2_b32 a[98:99], v6 offset0:130 offset1:131
    s_waitcnt lgkmcnt(12)
    v_mfma_f32_16x16x32_bf16 v[16:19], a[140:143], v[60:63], v[16:19]
    ds_read2_b32 a[100:101], v6 offset0:144 offset1:145
    ds_read2_b32 a[102:103], v6 offset0:146 offset1:147
    s_waitcnt lgkmcnt(12)
    v_mfma_f32_16x16x32_bf16 v[16:19], a[144:147], v[64:67], v[16:19]
    ds_read_b128 v[56:59], v4 offset:3200
    ds_read_b128 v[60:63], v4 offset:3264
    s_waitcnt lgkmcnt(12)
    v_mfma_f32_16x16x32_bf16 v[16:19], a[148:151], v[68:71], v[16:19]
    ds_read2_b32 a[104:105], v6 offset0:160 offset1:161
    ds_read2_b32 a[106:107], v6 offset0:162 offset1:163
    s_waitcnt lgkmcnt(12)
    v_mfma_f32_16x16x32_bf16 v[16:19], a[152:155], v[72:75], v[16:19]
    ds_read2_b32 a[108:109], v6 offset0:176 offset1:177
    ds_read2_b32 a[110:111], v6 offset0:178 offset1:179
    s_waitcnt lgkmcnt(12)
    v_mfma_f32_16x16x32_bf16 v[16:19], a[156:159], v[76:79], v[16:19]
    ds_read_b128 v[64:67], v4 offset:3328
    ds_read_b128 v[68:71], v4 offset:3392
    s_waitcnt lgkmcnt(13)
    v_mfma_f32_16x16x32_bf16 v[28:31], a[32:35], v[48:51], v[28:31]
    ds_read_b128 v[72:75], v4 offset:3456
    v_mfma_f32_16x16x32_bf16 v[24:27], a[0:3], v[48:51], v[24:27]
    v_mfma_f32_16x16x32_bf16 v[20:23], a[128:131], v[48:51], v[20:23]
    s_waitcnt lgkmcnt(11)
    v_mfma_f32_16x16x32_bf16 v[16:19], a[96:99], v[48:51], v[16:19]
    ds_read2_b32 a[112:113], v6 offset0:192 offset1:193
    ds_read2_b32 a[114:115], v6 offset0:194 offset1:195
    v_mfma_f32_16x16x32_bf16 v[28:31], a[36:39], v[52:55], v[28:31]
    ds_read_b128 v[76:79], v4 offset:3520
    v_mfma_f32_16x16x32_bf16 v[24:27], a[4:7], v[52:55], v[24:27]
    v_mfma_f32_16x16x32_bf16 v[20:23], a[132:135], v[52:55], v[20:23]
    s_waitcnt lgkmcnt(12)
    v_mfma_f32_16x16x32_bf16 v[16:19], a[100:103], v[52:55], v[16:19]
    ds_read2_b32 a[116:117], v6 offset0:208 offset1:209
    ds_read2_b32 a[118:119], v6 offset0:210 offset1:211
    s_waitcnt lgkmcnt(13)
    v_mfma_f32_16x16x32_bf16 v[28:31], a[40:43], v[56:59], v[28:31]
    s_waitcnt vmcnt(6)
    ds_read_b128 v[48:51], v4 offset:2560
    v_mfma_f32_16x16x32_bf16 v[24:27], a[8:11], v[56:59], v[24:27]
    v_mfma_f32_16x16x32_bf16 v[20:23], a[136:139], v[56:59], v[20:23]
    s_waitcnt lgkmcnt(11)
    v_mfma_f32_16x16x32_bf16 v[16:19], a[104:107], v[56:59], v[16:19]
    ds_read2_b32 a[120:121], v6 offset0:224 offset1:225
    ds_read2_b32 a[122:123], v6 offset0:226 offset1:227
    v_mfma_f32_16x16x32_bf16 v[28:31], a[44:47], v[60:63], v[28:31]
    ds_read_b128 v[52:55], v4 offset:2624
    v_mfma_f32_16x16x32_bf16 v[24:27], a[12:15], v[60:63], v[24:27]
    v_mfma_f32_16x16x32_bf16 v[20:23], a[140:143], v[60:63], v[20:23]
    s_waitcnt lgkmcnt(12)
    v_mfma_f32_16x16x32_bf16 v[16:19], a[108:111], v[60:63], v[16:19]
    ds_read2_b32 a[124:125], v6 offset0:240 offset1:241
    ds_read2_b32 a[126:127], v6 offset0:242 offset1:243
    s_waitcnt lgkmcnt(13)
    v_mfma_f32_16x16x32_bf16 v[28:31], a[48:51], v[64:67], v[28:31]
    ds_read_b128 v[56:59], v4 offset:2688
    v_mfma_f32_16x16x32_bf16 v[24:27], a[16:19], v[64:67], v[24:27]
    v_mfma_f32_16x16x32_bf16 v[20:23], a[144:147], v[64:67], v[20:23]
    s_waitcnt lgkmcnt(10)
    v_mfma_f32_16x16x32_bf16 v[16:19], a[112:115], v[64:67], v[16:19]
    s_waitcnt vmcnt(4)
    ds_read2_b32 a[64:65], v6 offset0:0 offset1:1
    ds_read2_b32 a[66:67], v6 offset0:2 offset1:3
    v_mfma_f32_16x16x32_bf16 v[28:31], a[52:55], v[68:71], v[28:31]
    ds_read2_b32 a[68:69], v6 offset0:16 offset1:17
    ds_read2_b32 a[70:71], v6 offset0:18 offset1:19
    v_mfma_f32_16x16x32_bf16 v[24:27], a[20:23], v[68:71], v[24:27]
    v_mfma_f32_16x16x32_bf16 v[20:23], a[148:151], v[68:71], v[20:23]
    s_waitcnt lgkmcnt(11)
    v_mfma_f32_16x16x32_bf16 v[16:19], a[116:119], v[68:71], v[16:19]
    ds_read2_b32 a[72:73], v6 offset0:32 offset1:33
    ds_read2_b32 a[74:75], v6 offset0:34 offset1:35
    v_mfma_f32_16x16x32_bf16 v[28:31], a[56:59], v[72:75], v[28:31]
    ds_read_b128 v[60:63], v4 offset:2752
    v_mfma_f32_16x16x32_bf16 v[24:27], a[24:27], v[72:75], v[24:27]
    v_mfma_f32_16x16x32_bf16 v[20:23], a[152:155], v[72:75], v[20:23]
    s_waitcnt lgkmcnt(11)
    v_mfma_f32_16x16x32_bf16 v[16:19], a[120:123], v[72:75], v[16:19]
    ds_read2_b32 a[76:77], v6 offset0:48 offset1:49
    ds_read2_b32 a[78:79], v6 offset0:50 offset1:51
    v_mfma_f32_16x16x32_bf16 v[28:31], a[60:63], v[76:79], v[28:31]
    ds_read_b128 v[64:67], v4 offset:2816
    v_mfma_f32_16x16x32_bf16 v[24:27], a[28:31], v[76:79], v[24:27]
    v_mfma_f32_16x16x32_bf16 v[20:23], a[156:159], v[76:79], v[20:23]
    s_waitcnt lgkmcnt(11)
    v_mfma_f32_16x16x32_bf16 v[16:19], a[124:127], v[76:79], v[16:19]
    ds_read2_b32 a[80:81], v6 offset0:64 offset1:65
    ds_read2_b32 a[82:83], v6 offset0:66 offset1:67
    v_mfma_f32_16x16x32_bf16 v[28:31], a[0:3], v[48:51], v[28:31]
    ds_read_b128 v[68:71], v4 offset:2880
    v_mfma_f32_16x16x32_bf16 v[24:27], a[128:131], v[48:51], v[24:27]
    v_mfma_f32_16x16x32_bf16 v[20:23], a[96:99], v[48:51], v[20:23]
    s_waitcnt lgkmcnt(11)
    v_mfma_f32_16x16x32_bf16 v[16:19], a[64:67], v[48:51], v[16:19]
    ds_read2_b32 a[84:85], v6 offset0:80 offset1:81
    ds_read2_b32 a[86:87], v6 offset0:82 offset1:83
    v_mfma_f32_16x16x32_bf16 v[28:31], a[4:7], v[52:55], v[28:31]
    ds_read_b128 v[72:75], v4 offset:2944
    v_mfma_f32_16x16x32_bf16 v[24:27], a[132:135], v[52:55], v[24:27]
    v_mfma_f32_16x16x32_bf16 v[20:23], a[100:103], v[52:55], v[20:23]
    s_waitcnt lgkmcnt(12)
    v_mfma_f32_16x16x32_bf16 v[16:19], a[68:71], v[52:55], v[16:19]
    ds_read2_b32 a[88:89], v6 offset0:96 offset1:97
    ds_read2_b32 a[90:91], v6 offset0:98 offset1:99
    v_mfma_f32_16x16x32_bf16 v[28:31], a[8:11], v[56:59], v[28:31]
    v_mfma_f32_16x16x32_bf16 v[24:27], a[136:139], v[56:59], v[24:27]
    v_mfma_f32_16x16x32_bf16 v[20:23], a[104:107], v[56:59], v[20:23]
    s_waitcnt lgkmcnt(12)
    v_mfma_f32_16x16x32_bf16 v[16:19], a[72:75], v[56:59], v[16:19]
    ds_read_b128 v[76:79], v4 offset:3008
    ds_read_b128 v[48:51], v4 offset:2048
    s_waitcnt lgkmcnt(13)
    v_mfma_f32_16x16x32_bf16 v[28:31], a[12:15], v[60:63], v[28:31]
    ds_read_b128 v[52:55], v4 offset:2112
    v_mfma_f32_16x16x32_bf16 v[24:27], a[140:143], v[60:63], v[24:27]
    v_mfma_f32_16x16x32_bf16 v[20:23], a[108:111], v[60:63], v[20:23]
    s_waitcnt lgkmcnt(12)
    v_mfma_f32_16x16x32_bf16 v[16:19], a[76:79], v[60:63], v[16:19]
    ds_read2_b32 a[92:93], v6 offset0:112 offset1:113
    ds_read2_b32 a[94:95], v6 offset0:114 offset1:115
    s_waitcnt lgkmcnt(13)
    v_mfma_f32_16x16x32_bf16 v[28:31], a[16:19], v[64:67], v[28:31]
    ds_read_b128 v[56:59], v4 offset:2176
    v_mfma_f32_16x16x32_bf16 v[24:27], a[144:147], v[64:67], v[24:27]
    v_mfma_f32_16x16x32_bf16 v[20:23], a[112:115], v[64:67], v[20:23]
    s_waitcnt lgkmcnt(12)
    v_mfma_f32_16x16x32_bf16 v[16:19], a[80:83], v[64:67], v[16:19]
    ds_read2_b32 a[32:33], v5 offset0:128 offset1:129
    ds_read2_b32 a[34:35], v5 offset0:130 offset1:131
    s_waitcnt lgkmcnt(13)
    v_mfma_f32_16x16x32_bf16 v[28:31], a[20:23], v[68:71], v[28:31]
    ds_read_b128 v[60:63], v4 offset:2240
    v_mfma_f32_16x16x32_bf16 v[24:27], a[148:151], v[68:71], v[24:27]
    v_mfma_f32_16x16x32_bf16 v[20:23], a[116:119], v[68:71], v[20:23]
    s_waitcnt lgkmcnt(12)
    v_mfma_f32_16x16x32_bf16 v[16:19], a[84:87], v[68:71], v[16:19]
    ds_read2_b32 a[36:37], v5 offset0:144 offset1:145
    ds_read2_b32 a[38:39], v5 offset0:146 offset1:147
    s_waitcnt lgkmcnt(13)
    v_mfma_f32_16x16x32_bf16 v[28:31], a[24:27], v[72:75], v[28:31]
    ds_read_b128 v[64:67], v4 offset:2304
    v_mfma_f32_16x16x32_bf16 v[24:27], a[152:155], v[72:75], v[24:27]
    v_mfma_f32_16x16x32_bf16 v[20:23], a[120:123], v[72:75], v[20:23]
    s_waitcnt lgkmcnt(12)
    v_mfma_f32_16x16x32_bf16 v[16:19], a[88:91], v[72:75], v[16:19]
    ds_read2_b32 a[40:41], v5 offset0:160 offset1:161
    ds_read2_b32 a[42:43], v5 offset0:162 offset1:163
    s_waitcnt lgkmcnt(13)
    v_mfma_f32_16x16x32_bf16 v[28:31], a[28:31], v[76:79], v[28:31]
    ds_read_b128 v[68:71], v4 offset:2368
    v_mfma_f32_16x16x32_bf16 v[24:27], a[156:159], v[76:79], v[24:27]
    v_mfma_f32_16x16x32_bf16 v[20:23], a[124:127], v[76:79], v[20:23]
    s_waitcnt lgkmcnt(10)
    v_mfma_f32_16x16x32_bf16 v[16:19], a[92:95], v[76:79], v[16:19]
    ds_read2_b32 a[44:45], v5 offset0:176 offset1:177
    ds_read2_b32 a[46:47], v5 offset0:178 offset1:179
    v_mfma_f32_16x16x32_bf16 v[28:31], a[128:131], v[48:51], v[28:31]
    ds_read2_b32 a[48:49], v5 offset0:192 offset1:193
    ds_read2_b32 a[50:51], v5 offset0:194 offset1:195
    v_mfma_f32_16x16x32_bf16 v[24:27], a[96:99], v[48:51], v[24:27]
    v_mfma_f32_16x16x32_bf16 v[20:23], a[64:67], v[48:51], v[20:23]
    s_waitcnt lgkmcnt(11)
    v_mfma_f32_16x16x32_bf16 v[16:19], a[32:35], v[48:51], v[16:19]
    ds_read2_b32 a[52:53], v5 offset0:208 offset1:209
    ds_read2_b32 a[54:55], v5 offset0:210 offset1:211
    v_mfma_f32_16x16x32_bf16 v[28:31], a[132:135], v[52:55], v[28:31]
    ds_read_b128 v[72:75], v4 offset:2432
    v_mfma_f32_16x16x32_bf16 v[24:27], a[100:103], v[52:55], v[24:27]
    v_mfma_f32_16x16x32_bf16 v[20:23], a[68:71], v[52:55], v[20:23]
    s_waitcnt lgkmcnt(11)
    v_mfma_f32_16x16x32_bf16 v[16:19], a[36:39], v[52:55], v[16:19]
    ds_read2_b32 a[56:57], v5 offset0:224 offset1:225
    ds_read2_b32 a[58:59], v5 offset0:226 offset1:227
    v_mfma_f32_16x16x32_bf16 v[28:31], a[136:139], v[56:59], v[28:31]
    ds_read_b128 v[76:79], v4 offset:2496
    v_mfma_f32_16x16x32_bf16 v[24:27], a[104:107], v[56:59], v[24:27]
    v_mfma_f32_16x16x32_bf16 v[20:23], a[72:75], v[56:59], v[20:23]
    s_waitcnt lgkmcnt(11)
    v_mfma_f32_16x16x32_bf16 v[16:19], a[40:43], v[56:59], v[16:19]
    ds_read2_b32 a[60:61], v5 offset0:240 offset1:241
    ds_read2_b32 a[62:63], v5 offset0:242 offset1:243
    v_mfma_f32_16x16x32_bf16 v[28:31], a[140:143], v[60:63], v[28:31]
    s_waitcnt vmcnt(3)
    ds_read_b128 v[48:51], v4 offset:1536
    v_mfma_f32_16x16x32_bf16 v[24:27], a[108:111], v[60:63], v[24:27]
    v_mfma_f32_16x16x32_bf16 v[20:23], a[76:79], v[60:63], v[20:23]
    s_waitcnt lgkmcnt(11)
    v_mfma_f32_16x16x32_bf16 v[16:19], a[44:47], v[60:63], v[16:19]
    s_waitcnt lgkmcnt(0)
    s_and_b32 s14, s8, 1
    s_lshl_b32 s14, s14, 4
    s_lshl_b32 s72, s72, 16
    s_lshr_b32 s76, s76, s14
    s_lshl_b32 s76, s76, 16
    s_cmp_eq_u32 s4, 1
    s_cselect_b32 s76, s76, 0
    v_mov_b32 v2, s72
    v_add_f32 v2, s76, v2
    v_cvt_pk_bf16_f32 v2, v2, v2
    ds_write_b16 v14, v2 offset:32
    ds_write_b16 v14, v2 offset:4190
    ds_read2_b32 a[0:1], v5 offset0:0 offset1:1
    ds_read2_b32 a[2:3], v5 offset0:2 offset1:3
    v_mfma_f32_16x16x32_bf16 v[28:31], a[144:147], v[64:67], v[28:31]
    ds_read_b128 v[52:55], v4 offset:1600
    ds_read2_b32 a[4:5], v5 offset0:16 offset1:17
    ds_read2_b32 a[6:7], v5 offset0:18 offset1:19
    v_mfma_f32_16x16x32_bf16 v[24:27], a[112:115], v[64:67], v[24:27]
    ds_read_b128 v[56:59], v4 offset:1664
    ds_read2_b32 a[8:9], v5 offset0:32 offset1:33
    ds_read2_b32 a[10:11], v5 offset0:34 offset1:35
    v_mfma_f32_16x16x32_bf16 v[20:23], a[80:83], v[64:67], v[20:23]
    ds_read_b128 v[60:63], v4 offset:1728
    ds_read2_b32 a[12:13], v5 offset0:48 offset1:49
    ds_read2_b32 a[14:15], v5 offset0:50 offset1:51
    v_mfma_f32_16x16x32_bf16 v[16:19], a[48:51], v[64:67], v[16:19]
    ds_read_b128 v[64:67], v4 offset:1792
    v_mfma_f32_16x16x32_bf16 v[28:31], a[148:151], v[68:71], v[28:31]
    v_mfma_f32_16x16x32_bf16 v[24:27], a[116:119], v[68:71], v[24:27]
    v_mfma_f32_16x16x32_bf16 v[20:23], a[84:87], v[68:71], v[20:23]
    v_mfma_f32_16x16x32_bf16 v[16:19], a[52:55], v[68:71], v[16:19]
    v_mfma_f32_16x16x32_bf16 v[28:31], a[152:155], v[72:75], v[28:31]
    v_mfma_f32_16x16x32_bf16 v[24:27], a[120:123], v[72:75], v[24:27]
    v_mfma_f32_16x16x32_bf16 v[20:23], a[88:91], v[72:75], v[20:23]
    v_mfma_f32_16x16x32_bf16 v[16:19], a[56:59], v[72:75], v[16:19]
    v_mfma_f32_16x16x32_bf16 v[28:31], a[156:159], v[76:79], v[28:31]
    v_mfma_f32_16x16x32_bf16 v[24:27], a[124:127], v[76:79], v[24:27]
    v_mfma_f32_16x16x32_bf16 v[20:23], a[92:95], v[76:79], v[20:23]
    v_mfma_f32_16x16x32_bf16 v[16:19], a[60:63], v[76:79], v[16:19]
    v_mfma_f32_16x16x32_bf16 v[28:31], a[96:99], v[48:51], v[28:31]
    v_mfma_f32_16x16x32_bf16 v[24:27], a[64:67], v[48:51], v[24:27]
    v_mfma_f32_16x16x32_bf16 v[20:23], a[32:35], v[48:51], v[20:23]
    s_waitcnt lgkmcnt(10)
    v_mfma_f32_16x16x32_bf16 v[16:19], a[0:3], v[48:51], v[16:19]
    ds_read2_b32 a[16:17], v5 offset0:64 offset1:65
    ds_read2_b32 a[18:19], v5 offset0:66 offset1:67
    s_waitcnt lgkmcnt(11)
    v_mfma_f32_16x16x32_bf16 v[28:31], a[100:103], v[52:55], v[28:31]
    ds_read_b128 v[68:71], v4 offset:1856
    ds_read2_b32 a[20:21], v5 offset0:80 offset1:81
    ds_read2_b32 a[22:23], v5 offset0:82 offset1:83
    v_mfma_f32_16x16x32_bf16 v[24:27], a[68:71], v[52:55], v[24:27]
    v_mfma_f32_16x16x32_bf16 v[20:23], a[36:39], v[52:55], v[20:23]
    s_waitcnt lgkmcnt(12)
    v_mfma_f32_16x16x32_bf16 v[16:19], a[4:7], v[52:55], v[16:19]
    ds_read_b128 v[72:75], v4 offset:1920
    ds_read_b128 v[76:79], v4 offset:1984
    s_waitcnt lgkmcnt(13)
    v_mfma_f32_16x16x32_bf16 v[28:31], a[104:107], v[56:59], v[28:31]
    ds_read_b128 v[48:51], v4 offset:1024
    v_mfma_f32_16x16x32_bf16 v[24:27], a[72:75], v[56:59], v[24:27]
    v_mfma_f32_16x16x32_bf16 v[20:23], a[40:43], v[56:59], v[20:23]
    s_waitcnt lgkmcnt(12)
    v_mfma_f32_16x16x32_bf16 v[16:19], a[8:11], v[56:59], v[16:19]
    ds_read2_b32 a[24:25], v5 offset0:96 offset1:97
    ds_read2_b32 a[26:27], v5 offset0:98 offset1:99
    s_waitcnt lgkmcnt(13)
    v_mfma_f32_16x16x32_bf16 v[28:31], a[108:111], v[60:63], v[28:31]
    ds_read_b128 v[52:55], v4 offset:1088
    v_mfma_f32_16x16x32_bf16 v[24:27], a[76:79], v[60:63], v[24:27]
    v_mfma_f32_16x16x32_bf16 v[20:23], a[44:47], v[60:63], v[20:23]
    s_waitcnt lgkmcnt(12)
    v_mfma_f32_16x16x32_bf16 v[16:19], a[12:15], v[60:63], v[16:19]
    ds_read2_b32 a[28:29], v5 offset0:112 offset1:113
    ds_read2_b32 a[30:31], v5 offset0:114 offset1:115
    s_waitcnt lgkmcnt(13)
    v_mfma_f32_16x16x32_bf16 v[28:31], a[112:115], v[64:67], v[28:31]
    ds_read_b128 v[56:59], v4 offset:1152
    v_mfma_f32_16x16x32_bf16 v[24:27], a[80:83], v[64:67], v[24:27]
    v_mfma_f32_16x16x32_bf16 v[20:23], a[48:51], v[64:67], v[20:23]
    s_waitcnt lgkmcnt(12)
    v_mfma_f32_16x16x32_bf16 v[16:19], a[16:19], v[64:67], v[16:19]
    ds_read_b128 v[60:63], v4 offset:1216
    ds_read_b128 v[64:67], v4 offset:1280
    s_waitcnt lgkmcnt(13)
    v_mfma_f32_16x16x32_bf16 v[28:31], a[116:119], v[68:71], v[28:31]
    v_mfma_f32_16x16x32_bf16 v[24:27], a[84:87], v[68:71], v[24:27]
    v_mfma_f32_16x16x32_bf16 v[20:23], a[52:55], v[68:71], v[20:23]
    s_waitcnt lgkmcnt(11)
    v_mfma_f32_16x16x32_bf16 v[16:19], a[20:23], v[68:71], v[16:19]
    ds_read_b128 v[68:71], v4 offset:1344
    s_waitcnt lgkmcnt(11)
    v_mfma_f32_16x16x32_bf16 v[28:31], a[120:123], v[72:75], v[28:31]
    v_mfma_f32_16x16x32_bf16 v[24:27], a[88:91], v[72:75], v[24:27]
    v_mfma_f32_16x16x32_bf16 v[20:23], a[56:59], v[72:75], v[20:23]
    s_waitcnt lgkmcnt(7)
    v_mfma_f32_16x16x32_bf16 v[16:19], a[24:27], v[72:75], v[16:19]
    ds_read_b128 v[72:75], v4 offset:1408
    v_mfma_f32_16x16x32_bf16 v[28:31], a[124:127], v[76:79], v[28:31]
    v_mfma_f32_16x16x32_bf16 v[24:27], a[92:95], v[76:79], v[24:27]
    v_mfma_f32_16x16x32_bf16 v[20:23], a[60:63], v[76:79], v[20:23]
    s_waitcnt lgkmcnt(5)
    v_mfma_f32_16x16x32_bf16 v[16:19], a[28:31], v[76:79], v[16:19]
    ds_read_b128 v[76:79], v4 offset:1472
    v_mfma_f32_16x16x32_bf16 v[28:31], a[64:67], v[48:51], v[28:31]
    v_mfma_f32_16x16x32_bf16 v[24:27], a[32:35], v[48:51], v[24:27]
    v_mfma_f32_16x16x32_bf16 v[20:23], a[0:3], v[48:51], v[20:23]
    s_waitcnt vmcnt(2)
    ds_read_b128 v[48:51], v4 offset:512
    v_mfma_f32_16x16x32_bf16 v[28:31], a[68:71], v[52:55], v[28:31]
    s_nop 0
    v_cvt_pk_bf16_f32 v84, v16, v17
    v_cvt_pk_bf16_f32 v85, v18, v19
    ds_write_b64 v9, v[84:85] offset:0
    v_mfma_f32_16x16x32_bf16 v[24:27], a[36:39], v[52:55], v[24:27]
    v_mfma_f32_16x16x32_bf16 v[20:23], a[4:7], v[52:55], v[20:23]
    ds_read_b128 v[52:55], v4 offset:576
    s_waitcnt lgkmcnt(8)
    v_mfma_f32_16x16x32_bf16 v[28:31], a[72:75], v[56:59], v[28:31]
    v_mfma_f32_16x16x32_bf16 v[24:27], a[40:43], v[56:59], v[24:27]
    v_mfma_f32_16x16x32_bf16 v[20:23], a[8:11], v[56:59], v[20:23]
    s_waitcnt lgkmcnt(1)
    s_barrier
    ds_read_b128 v[56:59], v4 offset:640
    v_mfma_f32_16x16x32_bf16 v[28:31], a[76:79], v[60:63], v[28:31]
    v_mfma_f32_16x16x32_bf16 v[24:27], a[44:47], v[60:63], v[24:27]
    v_mfma_f32_16x16x32_bf16 v[20:23], a[12:15], v[60:63], v[20:23]
    ds_read_b128 v[60:63], v4 offset:704
    v_mfma_f32_16x16x32_bf16 v[28:31], a[80:83], v[64:67], v[28:31]
    v_mfma_f32_16x16x32_bf16 v[24:27], a[48:51], v[64:67], v[24:27]
    v_mfma_f32_16x16x32_bf16 v[20:23], a[16:19], v[64:67], v[20:23]
    ds_read_b128 v[64:67], v4 offset:768
    v_mfma_f32_16x16x32_bf16 v[28:31], a[84:87], v[68:71], v[28:31]
    v_mfma_f32_16x16x32_bf16 v[24:27], a[52:55], v[68:71], v[24:27]
    v_mfma_f32_16x16x32_bf16 v[20:23], a[20:23], v[68:71], v[20:23]
    ds_read_b128 v[68:71], v4 offset:832
    v_mfma_f32_16x16x32_bf16 v[28:31], a[88:91], v[72:75], v[28:31]
    v_mfma_f32_16x16x32_bf16 v[24:27], a[56:59], v[72:75], v[24:27]
    v_mfma_f32_16x16x32_bf16 v[20:23], a[24:27], v[72:75], v[20:23]
    ds_read_b128 v[72:75], v4 offset:896
    v_mfma_f32_16x16x32_bf16 v[28:31], a[92:95], v[76:79], v[28:31]
    v_mfma_f32_16x16x32_bf16 v[24:27], a[60:63], v[76:79], v[24:27]
    v_mfma_f32_16x16x32_bf16 v[20:23], a[28:31], v[76:79], v[20:23]
    ds_read_b128 v[76:79], v4 offset:960
    v_mfma_f32_16x16x32_bf16 v[28:31], a[32:35], v[48:51], v[28:31]
    v_mfma_f32_16x16x32_bf16 v[24:27], a[0:3], v[48:51], v[24:27]
    ds_read_b128 v[48:51], v4 offset:0
    s_waitcnt lgkmcnt(7)
    v_mfma_f32_16x16x32_bf16 v[28:31], a[36:39], v[52:55], v[28:31]
    v_mfma_f32_16x16x32_bf16 v[24:27], a[4:7], v[52:55], v[24:27]
    s_nop 0
    v_cvt_pk_bf16_f32 v84, v20, v21
    v_cvt_pk_bf16_f32 v85, v22, v23
    ds_write_b64 v9, v[84:85] offset:640
    ds_read_b128 v[52:55], v4 offset:64
    s_waitcnt lgkmcnt(8)
    v_mfma_f32_16x16x32_bf16 v[28:31], a[40:43], v[56:59], v[28:31]
    v_mfma_f32_16x16x32_bf16 v[24:27], a[8:11], v[56:59], v[24:27]
    ds_read_b128 v[56:59], v4 offset:128
    s_waitcnt lgkmcnt(8)
    v_mfma_f32_16x16x32_bf16 v[28:31], a[44:47], v[60:63], v[28:31]
    v_mfma_f32_16x16x32_bf16 v[24:27], a[12:15], v[60:63], v[24:27]
    ds_read_b128 v[60:63], v4 offset:192
    s_waitcnt lgkmcnt(8)
    v_mfma_f32_16x16x32_bf16 v[28:31], a[48:51], v[64:67], v[28:31]
    s_waitcnt lgkmcnt(3)
    s_barrier
    ds_read_b64_tr_b16 v[88:89], v10 offset:640
    ds_read_b64_tr_b16 v[90:91], v10 offset:11136
    v_mfma_f32_16x16x32_bf16 v[24:27], a[16:19], v[64:67], v[24:27]
    ds_read_b128 v[64:67], v4 offset:256
    v_mfma_f32_16x16x32_bf16 v[28:31], a[52:55], v[68:71], v[28:31]
    v_mfma_f32_16x16x32_bf16 v[24:27], a[20:23], v[68:71], v[24:27]
    ds_read_b128 v[68:71], v4 offset:320
    v_mfma_f32_16x16x32_bf16 v[28:31], a[56:59], v[72:75], v[28:31]
    s_waitcnt vmcnt(1)
    s_waitcnt lgkmcnt(2)
    v_and_or_b32 v92, v32, v86, s67
    v_and_or_b32 v93, v32, v87, s69
    v_mfma_f32_16x16x32_bf16 v[24:27], a[24:27], v[72:75], v[24:27]
    ds_read_b128 v[72:75], v4 offset:384
    v_and_or_b32 v94, v33, v86, s67
    v_and_or_b32 v95, v33, v87, s69
    v_dot2_f32_bf16 v92, v88, v92, 0
    v_mfma_f32_16x16x32_bf16 v[28:31], a[60:63], v[76:79], v[28:31]
    v_dot2_f32_bf16 v93, v88, v93, 0
    v_dot2_f32_bf16 v94, v89, v94, 0
    v_dot2_f32_bf16 v95, v89, v95, 0
    v_mfma_f32_16x16x32_bf16 v[24:27], a[28:31], v[76:79], v[24:27]
    ds_read_b128 v[76:79], v4 offset:448
    s_nop 1
    v_cvt_pk_bf16_f32 v88, v92, v93
    v_cvt_pk_bf16_f32 v89, v94, v95
    v_mfma_f32_16x16x32_bf16 v[28:31], a[0:3], v[48:51], v[28:31]
    v_and_or_b32 v92, v34, v86, s67
    v_and_or_b32 v93, v34, v87, s69
    v_and_or_b32 v94, v35, v86, s67
    v_mfma_f32_16x16x32_bf16 v[28:31], a[4:7], v[52:55], v[28:31]
    v_and_or_b32 v95, v35, v87, s69
    v_dot2_f32_bf16 v92, v90, v92, 0
    v_dot2_f32_bf16 v93, v90, v93, 0
    v_mfma_f32_16x16x32_bf16 v[28:31], a[8:11], v[56:59], v[28:31]
    v_dot2_f32_bf16 v94, v91, v94, 0
    v_dot2_f32_bf16 v95, v91, v95, 0
    s_nop 1
    v_mfma_f32_16x16x32_bf16 v[28:31], a[12:15], v[60:63], v[28:31]
    v_cvt_pk_bf16_f32 v84, v24, v25
    v_cvt_pk_bf16_f32 v85, v26, v27
    ds_write_b64 v9, v[84:85] offset:1280
    v_cvt_pk_bf16_f32 v90, v92, v93
    v_cvt_pk_bf16_f32 v91, v94, v95
    s_mov_b32 s68, 3276800
    buffer_store_dwordx4 v[88:91], v11, s[60:63], s68 offen
    s_waitcnt lgkmcnt(4)
    v_mfma_f32_16x16x32_bf16 v[28:31], a[16:19], v[64:67], v[28:31]
    s_waitcnt lgkmcnt(3)
    v_mfma_f32_16x16x32_bf16 v[28:31], a[20:23], v[68:71], v[28:31]
    s_waitcnt lgkmcnt(2)
    v_mfma_f32_16x16x32_bf16 v[28:31], a[24:27], v[72:75], v[28:31]
    s_waitcnt lgkmcnt(1)
    v_mfma_f32_16x16x32_bf16 v[28:31], a[28:31], v[76:79], v[28:31]
    s_nop 7
    v_cvt_pk_bf16_f32 v84, v28, v29
    v_cvt_pk_bf16_f32 v85, v30, v31
    ds_write_b64 v9, v[84:85] offset:1920
    s_waitcnt lgkmcnt(1)
    s_barrier
    s_waitcnt lgkmcnt(0)
    s_barrier
    ds_read_b64_tr_b16 v[88:89], v10 offset:1920
    ds_read_b64_tr_b16 v[90:91], v10 offset:12416
    s_waitcnt vmcnt(1)
    s_waitcnt lgkmcnt(0)
    v_and_or_b32 v92, v36, v86, s67
    v_and_or_b32 v93, v36, v87, s69
    v_and_or_b32 v94, v37, v86, s67
    v_and_or_b32 v95, v37, v87, s69
    v_dot2_f32_bf16 v92, v88, v92, 0
    v_dot2_f32_bf16 v93, v88, v93, 0
    v_dot2_f32_bf16 v94, v89, v94, 0
    v_dot2_f32_bf16 v95, v89, v95, 0
    s_nop 1
    v_cvt_pk_bf16_f32 v88, v92, v93
    v_cvt_pk_bf16_f32 v89, v94, v95
    v_and_or_b32 v92, v38, v86, s67
    v_and_or_b32 v93, v38, v87, s69
    v_and_or_b32 v94, v39, v86, s67
    v_and_or_b32 v95, v39, v87, s69
    v_dot2_f32_bf16 v92, v90, v92, 0
    v_dot2_f32_bf16 v93, v90, v93, 0
    v_dot2_f32_bf16 v94, v91, v94, 0
    v_dot2_f32_bf16 v95, v91, v95, 0
    s_nop 1
    v_cvt_pk_bf16_f32 v90, v92, v93
    v_cvt_pk_bf16_f32 v91, v94, v95
    s_mov_b32 s68, 4587520
    buffer_store_dwordx4 v[88:91], v11, s[60:63], s68 offen
L_end_T1:
    s_endpgm
L_T2:
    s_cmp_ge_u32 s7, 5
    s_cselect_b32 s4, 1, 0
    s_mul_i32 s8, s4, 5
    s_sub_u32 s7, s7, s8
    s_lshl_b32 s7, s7, 1
    s_add_u32 s5, s5, s7
    s_lshl_b32 s8, s5, 3
    s_add_u32 s8, s8, s3
    s_mul_i32 s9, s4, 640
    s_add_u32 s9, s9, s8
    s_lshl_b32 s10, s8, 12
    s_lshl_b32 s13, s9, 12
    s_add_u32 s13, s13, 2048
    s_mul_i32 s70, s3, 2560
    s_mul_i32 s71, s3, 4224
    s_add_u32 s71, s71, 40960
    v_lshlrev_b32 v13, 4, v1
    v_and_b32 v88, 15, v1
    v_lshrrev_b32 v89, 4, v1
    v_lshlrev_b32 v90, 5, v88
    v_lshlrev_b32 v91, 4, v89
    v_sub_u32 v90, v91, v90
    s_add_u32 s14, s70, 480
    v_add_u32 v4, s14, v90
    v_add_u32 v90, 1, v88
    v_and_b32 v91, 1, v90
    v_lshl_add_u32 v90, v89, 3, v90
    v_lshrrev_b32 v90, 1, v90
    v_lshlrev_b32 v90, 2, v90
    v_mul_u32_u24 v91, 2112, v91
    v_add_u32 v90, v90, v91
    v_add_u32 v5, s71, v90
    v_add_u32 v6, 1024, v5
    v_add_u32 v7, 33792, v5
    v_add_u32 v8, 34816, v5
    s_add_u32 s14, s70, 2048
    v_lshl_add_u32 v90, v1, 4, s14
    s_sub_u32 s14, s71, 480
    v_lshl_add_u32 v91, v1, 4, s14
    s_add_u32 s14, s71, 1600
    v_lshl_add_u32 v92, v1, 4, s14
    v_cmp_gt_u32 vcc, 32, v1
    v_mov_b32 v93, 33792
    v_mov_b32 v94, 20480
    v_cndmask_b32 v91, v92, v91, vcc
    v_cmp_gt_u32 vcc, 30, v1
    v_mov_b32 v80, 0
    v_mov_b32 v81, 0
    v_mov_b32 v82, 0
    v_mov_b32 v83, 0
    v_cndmask_b32 v90, v91, v90, vcc
    v_cndmask_b32 v93, v93, v94, vcc
    s_mov_b32 exec_hi, 3
    ds_write_b128 v90, v[80:83]
    v_add_u32 v90, v90, v93
    ds_write_b128 v90, v[80:83]
    s_mov_b64 exec, -1
    v_mov_b32 v14, s71
    s_mov_b32 s50, 5242880
    s_mov_b32 s51, 0x00020000
    s_mov_b32 s54, 2621440
    s_mov_b32 s55, 0x00020000
    s_waitcnt lgkmcnt(0)
    s_mov_b32 s48, s46
    s_and_b32 s49, s47, 0xffff
    s_add_u32 s6, s46, 5242880
    s_addc_u32 s7, s47, 0
    s_cmp_eq_u32 s4, 1
    s_cselect_b32 s6, s38, s6
    s_cselect_b32 s7, s39, s7
    s_mov_b32 s52, s6
    s_and_b32 s53, s7, 0xffff
    s_cmp_ge_u32 s3, 4
    s_cbranch_scc1 L_xdma_13
    s_add_u32 s15, s13, 0
    s_add_u32 m0, s70, 0
    s_nop 0
    buffer_load_dwordx4 v13, s[48:51], s15 offen offset:1024 lds
    s_add_u32 s15, s10, 0
    s_add_u32 m0, s71, 32
    s_nop 0
    buffer_load_dwordx4 v13, s[52:55], s15 offen offset:1024 lds
    s_add_u32 s15, s10, 2
    s_add_u32 m0, s71, 2144
    s_nop 0
    buffer_load_dwordx4 v13, s[52:55], s15 offen offset:1024 lds
L_xdma_13:
    s_mul_i32 s14, s3, 4672
    s_add_u32 s14, s14, 108544
    s_lshl_b32 s11, s5, 4
    v_mul_u32_u24 v90, 72, v88
    v_lshl_add_u32 v90, v89, 4, v90
    v_add_u32 v9, s14, v90
    v_bfe_u32 v90, v1, 2, 2
    v_mul_u32_u24 v90, 4672, v90
    v_and_b32 v91, 3, v1
    v_lshl_add_u32 v90, v91, 3, v90
    v_lshrrev_b32 v91, 1, v89
    v_mul_u32_u24 v91, 72, v91
    v_add_u32 v90, v90, v91
    v_and_b32 v91, 1, v89
    v_lshl_add_u32 v90, v91, 5, v90
    s_mul_i32 s14, s3, 144
    s_add_u32 s14, s14, 108544
    v_add_u32 v10, s14, v90
    s_lshl_b32 s14, s3, 5
    v_lshrrev_b32 v90, 1, v1
    v_add_u32 v90, s14, v90
    v_and_b32 v91, 1, v1
    v_lshlrev_b32 v91, 4, v91
    v_add_u32 v91, s11, v91
    v_mul_u32_u24 v12, 1280, v90
    v_add_u32 v12, v12, v91
    v_mul_u32_u24 v11, 2560, v90
    v_add_u32 v11, v11, v91
    s_mul_i32 s14, s4, 1280
    v_add_u32 v11, s14, v11
    s_cmp_ge_u32 s3, 4
    s_cbranch_scc1 L_xdma2_14
    s_add_u32 s15, s10, 0
    s_add_u32 m0, s71, 32
    s_nop 0
    buffer_load_dwordx4 v13, s[52:55], s15 offen offset:0 lds
    s_add_u32 s15, s10, 2
    s_add_u32 m0, s71, 2144
    s_nop 0
    buffer_load_dwordx4 v13, s[52:55], s15 offen offset:0 lds
L_xdma2_14:
    s_add_u32 s14, s10, 0
    s_load_dword s72, s[6:7], s14
    s_add_u32 s14, s10, 32768
    s_load_dword s73, s[6:7], s14
    s_lshl_b32 s11, s8, 1
    s_and_b32 s11, s11, 0xfffffffc
    s_add_u32 s14, s11, 0
    s_load_dword s76, s[40:41], s14
    s_add_u32 s14, s11, 16
    s_load_dword s77, s[40:41], s14
    s_mov_b32 s56, s30
    s_and_b32 s57, s31, 0xffff
    s_mov_b32 s59, 0x00020000
    s_mov_b32 s60, s42
    s_and_b32 s61, s43, 0xffff
    s_mov_b32 s62, 5242880
    s_mov_b32 s63, 0x00020000
    s_cmp_eq_u32 s4, 1
    s_cselect_b32 s58, 2621440, 0
    s_cselect_b32 s69, 0, 0x3f800000
    s_cselect_b32 s67, 0, 0x3f80
    v_mov_b32 v86, 0xffff
    v_mov_b32 v87, 0xffff0000
    s_cmp_ge_u32 s3, 4
    s_cbranch_scc1 L_T2_Y
    s_waitcnt vmcnt(4)
    ds_read_b128 v[48:51], v4 offset:1536
    s_waitcnt vmcnt(2)
    ds_read2_b32 a[96:97], v6 offset0:128 offset1:129
    ds_read2_b32 a[98:99], v6 offset0:130 offset1:131
    ds_read_b128 v[52:55], v4 offset:1600
    ds_read2_b32 a[100:101], v6 offset0:144 offset1:145
    ds_read2_b32 a[102:103], v6 offset0:146 offset1:147
    ds_read_b128 v[56:59], v4 offset:1664
    s_waitcnt lgkmcnt(4)
    v_mfma_f32_16x16x32_bf16 v[28:31], a[96:99], v[48:51], 0
    s_barrier
    s_add_u32 s15, s13, 0
    s_add_u32 m0, s70, 0
    s_nop 0
    buffer_load_dwordx4 v13, s[48:51], s15 offen offset:0 lds
    ds_read2_b32 a[104:105], v6 offset0:160 offset1:161
    ds_read2_b32 a[106:107], v6 offset0:162 offset1:163
    ds_read_b128 v[60:63], v4 offset:1728
    ds_read2_b32 a[108:109], v6 offset0:176 offset1:177
    ds_read2_b32 a[110:111], v6 offset0:178 offset1:179
    s_waitcnt lgkmcnt(6)
    v_mfma_f32_16x16x32_bf16 v[28:31], a[100:103], v[52:55], v[28:31]
    ds_read_b128 v[64:67], v4 offset:1792
    ds_read2_b32 a[112:113], v6 offset0:192 offset1:193
    ds_read2_b32 a[114:115], v6 offset0:194 offset1:195
    ds_read_b128 v[68:71], v4 offset:1856
    s_waitcnt lgkmcnt(7)
    v_mfma_f32_16x16x32_bf16 v[28:31], a[104:107], v[56:59], v[28:31]
    ds_read2_b32 a[116:117], v6 offset0:208 offset1:209
    ds_read2_b32 a[118:119], v6 offset0:210 offset1:211
    ds_read_b128 v[72:75], v4 offset:1920
    ds_read2_b32 a[120:121], v6 offset0:224 offset1:225
    ds_read2_b32 a[122:123], v6 offset0:226 offset1:227
    s_waitcnt lgkmcnt(9)
    v_mfma_f32_16x16x32_bf16 v[28:31], a[108:111], v[60:63], v[28:31]
    ds_read_b128 v[76:79], v4 offset:1984
    ds_read2_b32 a[124:125], v6 offset0:240 offset1:241
    ds_read2_b32 a[126:127], v6 offset0:242 offset1:243
    s_waitcnt vmcnt(1)
    ds_read2_b32 a[64:65], v6 offset0:0 offset1:1
    ds_read2_b32 a[66:67], v6 offset0:2 offset1:3
    s_waitcnt lgkmcnt(11)
    v_mfma_f32_16x16x32_bf16 v[28:31], a[112:115], v[64:67], v[28:31]
    ds_read2_b32 a[68:69], v6 offset0:16 offset1:17
    ds_read2_b32 a[70:71], v6 offset0:18 offset1:19
    s_waitcnt lgkmcnt(10)
    v_mfma_f32_16x16x32_bf16 v[28:31], a[116:119], v[68:71], v[28:31]
    ds_read2_b32 a[72:73], v6 offset0:32 offset1:33
    ds_read2_b32 a[74:75], v6 offset0:34 offset1:35
    ds_read2_b32 a[76:77], v6 offset0:48 offset1:49
    ds_read2_b32 a[78:79], v6 offset0:50 offset1:51
    s_waitcnt lgkmcnt(11)
    v_mfma_f32_16x16x32_bf16 v[28:31], a[120:123], v[72:75], v[28:31]
    ds_read2_b32 a[80:81], v6 offset0:64 offset1:65
    ds_read2_b32 a[82:83], v6 offset0:66 offset1:67
    s_waitcnt lgkmcnt(10)
    v_mfma_f32_16x16x32_bf16 v[28:31], a[124:127], v[76:79], v[28:31]
    ds_read2_b32 a[84:85], v6 offset0:80 offset1:81
    ds_read2_b32 a[86:87], v6 offset0:82 offset1:83
    ds_read2_b32 a[88:89], v6 offset0:96 offset1:97
    ds_read2_b32 a[90:91], v6 offset0:98 offset1:99
    s_waitcnt lgkmcnt(12)
    v_mfma_f32_16x16x32_bf16 v[24:27], a[64:67], v[48:51], 0
    ds_read2_b32 a[92:93], v6 offset0:112 offset1:113
    ds_read2_b32 a[94:95], v6 offset0:114 offset1:115
    s_waitcnt lgkmcnt(12)
    v_mfma_f32_16x16x32_bf16 v[24:27], a[68:71], v[52:55], v[24:27]
    ds_read2_b32 a[32:33], v5 offset0:128 offset1:129
    ds_read2_b32 a[34:35], v5 offset0:130 offset1:131
    s_waitcnt lgkmcnt(12)
    v_mfma_f32_16x16x32_bf16 v[24:27], a[72:75], v[56:59], v[24:27]
    ds_read2_b32 a[36:37], v5 offset0:144 offset1:145
    ds_read2_b32 a[38:39], v5 offset0:146 offset1:147
    s_waitcnt lgkmcnt(12)
    v_mfma_f32_16x16x32_bf16 v[24:27], a[76:79], v[60:63], v[24:27]
    s_add_u32 s15, s13, 32768
    s_add_u32 m0, s70, 20480
    s_nop 0
    buffer_load_dwordx4 v13, s[48:51], s15 offen offset:1024 lds
    ds_read2_b32 a[40:41], v5 offset0:160 offset1:161
    ds_read2_b32 a[42:43], v5 offset0:162 offset1:163
    s_waitcnt lgkmcnt(12)
    v_mfma_f32_16x16x32_bf16 v[24:27], a[80:83], v[64:67], v[24:27]
    ds_read2_b32 a[44:45], v5 offset0:176 offset1:177
    ds_read2_b32 a[46:47], v5 offset0:178 offset1:179
    s_waitcnt lgkmcnt(12)
    v_mfma_f32_16x16x32_bf16 v[24:27], a[84:87], v[68:71], v[24:27]
    ds_read2_b32 a[48:49], v5 offset0:192 offset1:193
    ds_read2_b32 a[50:51], v5 offset0:194 offset1:195
    s_waitcnt lgkmcnt(12)
    v_mfma_f32_16x16x32_bf16 v[24:27], a[88:91], v[72:75], v[24:27]
    ds_read2_b32 a[52:53], v5 offset0:208 offset1:209
    ds_read2_b32 a[54:55], v5 offset0:210 offset1:211
    s_waitcnt lgkmcnt(12)
    v_mfma_f32_16x16x32_bf16 v[24:27], a[92:95], v[76:79], v[24:27]
    ds_read2_b32 a[56:57], v5 offset0:224 offset1:225
    ds_read2_b32 a[58:59], v5 offset0:226 offset1:227
    s_waitcnt lgkmcnt(12)
    v_mfma_f32_16x16x32_bf16 v[20:23], a[32:35], v[48:51], 0
    s_add_u32 s15, s10, 32768
    s_add_u32 m0, s71, 33824
    s_nop 0
    buffer_load_dwordx4 v13, s[52:55], s15 offen offset:1024 lds
    ds_read2_b32 a[60:61], v5 offset0:240 offset1:241
    ds_read2_b32 a[62:63], v5 offset0:242 offset1:243
    s_waitcnt lgkmcnt(12)
    v_mfma_f32_16x16x32_bf16 v[20:23], a[36:39], v[52:55], v[20:23]
    s_waitcnt lgkmcnt(0)
    s_and_b32 s14, s8, 1
    s_lshl_b32 s14, s14, 4
    s_lshl_b32 s72, s72, 16
    s_lshr_b32 s76, s76, s14
    s_lshl_b32 s76, s76, 16
    s_lshl_b32 s73, s73, 16
    s_lshr_b32 s77, s77, s14
    s_lshl_b32 s77, s77, 16
    s_cmp_eq_u32 s4, 1
    s_cselect_b32 s76, s76, 0
    s_cselect_b32 s77, s77, 0
    v_mov_b32 v2, s72
    v_add_f32 v2, s76, v2
    v_cvt_pk_bf16_f32 v2, v2, v2
    v_mov_b32 v3, s73
    v_add_f32 v3, s77, v3
    v_cvt_pk_bf16_f32 v3, v3, v3
    ds_write_b16 v14, v2 offset:32
    ds_write_b16 v14, v2 offset:2142
    ds_read2_b32 a[0:1], v5 offset0:0 offset1:1
    ds_read2_b32 a[2:3], v5 offset0:2 offset1:3
    ds_read2_b32 a[4:5], v5 offset0:16 offset1:17
    ds_read2_b32 a[6:7], v5 offset0:18 offset1:19
    v_mfma_f32_16x16x32_bf16 v[20:23], a[40:43], v[56:59], v[20:23]
    ds_read2_b32 a[8:9], v5 offset0:32 offset1:33
    ds_read2_b32 a[10:11], v5 offset0:34 offset1:35
    ds_read2_b32 a[12:13], v5 offset0:48 offset1:49
    ds_read2_b32 a[14:15], v5 offset0:50 offset1:51
    v_mfma_f32_16x16x32_bf16 v[20:23], a[44:47], v[60:63], v[20:23]
    ds_read2_b32 a[16:17], v5 offset0:64 offset1:65
    ds_read2_b32 a[18:19], v5 offset0:66 offset1:67
    ds_read2_b32 a[20:21], v5 offset0:80 offset1:81
    ds_read2_b32 a[22:23], v5 offset0:82 offset1:83
    v_mfma_f32_16x16x32_bf16 v[20:23], a[48:51], v[64:67], v[20:23]
    v_mfma_f32_16x16x32_bf16 v[20:23], a[52:55], v[68:71], v[20:23]
    s_add_u32 s15, s10, 32770
    s_add_u32 m0, s71, 35936
    s_nop 0
    buffer_load_dwordx4 v13, s[52:55], s15 offen offset:1024 lds
    v_mfma_f32_16x16x32_bf16 v[20:23], a[56:59], v[72:75], v[20:23]
    v_mfma_f32_16x16x32_bf16 v[20:23], a[60:63], v[76:79], v[20:23]
    s_waitcnt lgkmcnt(10)
    v_mfma_f32_16x16x32_bf16 v[16:19], a[0:3], v[48:51], 0
    ds_read2_b32 a[24:25], v5 offset0:96 offset1:97
    ds_read2_b32 a[26:27], v5 offset0:98 offset1:99
    ds_read2_b32 a[28:29], v5 offset0:112 offset1:113
    ds_read2_b32 a[30:31], v5 offset0:114 offset1:115
    s_waitcnt lgkmcnt(12)
    v_mfma_f32_16x16x32_bf16 v[16:19], a[4:7], v[52:55], v[16:19]
    ds_read_b128 v[48:51], v4 offset:1024
    ds_read_b128 v[52:55], v4 offset:1088
    s_waitcnt lgkmcnt(12)
    v_mfma_f32_16x16x32_bf16 v[16:19], a[8:11], v[56:59], v[16:19]
    s_add_u32 s15, s10, 32768
    s_add_u32 m0, s71, 33824
    s_nop 0
    buffer_load_dwordx4 v13, s[52:55], s15 offen offset:0 lds
    ds_read_b128 v[56:59], v4 offset:1152
    s_waitcnt lgkmcnt(11)
    v_mfma_f32_16x16x32_bf16 v[16:19], a[12:15], v[60:63], v[16:19]
    ds_read_b128 v[60:63], v4 offset:1216
    s_waitcnt lgkmcnt(10)
    v_mfma_f32_16x16x32_bf16 v[16:19], a[16:19], v[64:67], v[16:19]
    ds_read_b128 v[64:67], v4 offset:1280
    s_waitcnt lgkmcnt(9)
    v_mfma_f32_16x16x32_bf16 v[16:19], a[20:23], v[68:71], v[16:19]
    ds_read_b128 v[68:71], v4 offset:1344
    s_waitcnt lgkmcnt(8)
    v_mfma_f32_16x16x32_bf16 v[16:19], a[24:27], v[72:75], v[16:19]
    ds_read_b128 v[72:75], v4 offset:1408
    s_waitcnt lgkmcnt(7)
    v_mfma_f32_16x16x32_bf16 v[16:19], a[28:31], v[76:79], v[16:19]
    s_add_u32 s15, s10, 32770
    s_add_u32 m0, s71, 35936
    s_nop 0
    buffer_load_dwordx4 v13, s[52:55], s15 offen offset:0 lds
    ds_read_b128 v[76:79], v4 offset:1472
    s_waitcnt lgkmcnt(7)
    v_mfma_f32_16x16x32_bf16 v[28:31], a[64:67], v[48:51], v[28:31]
    v_mfma_f32_16x16x32_bf16 v[24:27], a[32:35], v[48:51], v[24:27]
    v_mfma_f32_16x16x32_bf16 v[20:23], a[0:3], v[48:51], v[20:23]
    s_waitcnt vmcnt(5)
    ds_read_b128 v[48:51], v4 offset:512
    s_waitcnt lgkmcnt(7)
    v_mfma_f32_16x16x32_bf16 v[28:31], a[68:71], v[52:55], v[28:31]
    v_cvt_pk_bf16_f32 v84, v16, v17
    v_cvt_pk_bf16_f32 v85, v18, v19
    ds_write_b16 v9, v84 offset:0
    ds_write_b16_d16_hi v9, v84 offset:4
    ds_write_b16 v9, v85 offset:8
    ds_write_b16_d16_hi v9, v85 offset:12
    v_mfma_f32_16x16x32_bf16 v[24:27], a[36:39], v[52:55], v[24:27]
    s_add_u32 s15, s13, 32768
    s_add_u32 m0, s70, 20480
    s_nop 0
    buffer_load_dwordx4 v13, s[48:51], s15 offen offset:0 lds
    v_mfma_f32_16x16x32_bf16 v[20:23], a[4:7], v[52:55], v[20:23]
    ds_read_b128 v[52:55], v4 offset:576
    s_waitcnt lgkmcnt(11)
    v_mfma_f32_16x16x32_bf16 v[28:31], a[72:75], v[56:59], v[28:31]
    v_mfma_f32_16x16x32_bf16 v[24:27], a[40:43], v[56:59], v[24:27]
    v_mfma_f32_16x16x32_bf16 v[20:23], a[8:11], v[56:59], v[20:23]
    ds_read_b128 v[56:59], v4 offset:640
    s_waitcnt lgkmcnt(11)
    v_mfma_f32_16x16x32_bf16 v[28:31], a[76:79], v[60:63], v[28:31]
    v_mfma_f32_16x16x32_bf16 v[24:27], a[44:47], v[60:63], v[24:27]
    v_mfma_f32_16x16x32_bf16 v[20:23], a[12:15], v[60:63], v[20:23]
    ds_read_b128 v[60:63], v4 offset:704
    s_waitcnt lgkmcnt(11)
    v_mfma_f32_16x16x32_bf16 v[28:31], a[80:83], v[64:67], v[28:31]
    v_mfma_f32_16x16x32_bf16 v[24:27], a[48:51], v[64:67], v[24:27]
    v_mfma_f32_16x16x32_bf16 v[20:23], a[16:19], v[64:67], v[20:23]
    ds_read_b128 v[64:67], v4 offset:768
    s_waitcnt lgkmcnt(11)
    v_mfma_f32_16x16x32_bf16 v[28:31], a[84:87], v[68:71], v[28:31]
    v_mfma_f32_16x16x32_bf16 v[24:27], a[52:55], v[68:71], v[24:27]
    s_mov_b32 s14, 0
    buffer_load_dwordx4 v[32:35], v12, s[56:59], s14 offen
    v_mfma_f32_16x16x32_bf16 v[20:23], a[20:23], v[68:71], v[20:23]
    ds_read_b128 v[68:71], v4 offset:832
    s_waitcnt lgkmcnt(11)
    v_mfma_f32_16x16x32_bf16 v[28:31], a[88:91], v[72:75], v[28:31]
    v_mfma_f32_16x16x32_bf16 v[24:27], a[56:59], v[72:75], v[24:27]
    v_mfma_f32_16x16x32_bf16 v[20:23], a[24:27], v[72:75], v[20:23]
    ds_read_b128 v[72:75], v4 offset:896
    s_waitcnt lgkmcnt(11)
    v_mfma_f32_16x16x32_bf16 v[28:31], a[92:95], v[76:79], v[28:31]
    v_mfma_f32_16x16x32_bf16 v[24:27], a[60:63], v[76:79], v[24:27]
    v_mfma_f32_16x16x32_bf16 v[20:23], a[28:31], v[76:79], v[20:23]
    ds_read_b128 v[76:79], v4 offset:960
    s_waitcnt lgkmcnt(11)
    v_mfma_f32_16x16x32_bf16 v[28:31], a[32:35], v[48:51], v[28:31]
    s_mov_b32 s14, 327680
    buffer_load_dwordx4 v[36:39], v12, s[56:59], s14 offen
    s_waitcnt vmcnt(5)
    ds_read2_b32 a[128:129], v8 offset0:128 offset1:129
    ds_read2_b32 a[130:131], v8 offset0:130 offset1:131
    v_mfma_f32_16x16x32_bf16 v[24:27], a[0:3], v[48:51], v[24:27]
    ds_read_b128 v[48:51], v4 offset:0
    s_waitcnt lgkmcnt(9)
    v_mfma_f32_16x16x32_bf16 v[28:31], a[36:39], v[52:55], v[28:31]
    s_waitcnt vmcnt(3)
    ds_read2_b32 a[96:97], v8 offset0:0 offset1:1
    ds_read2_b32 a[98:99], v8 offset0:2 offset1:3
    v_mfma_f32_16x16x32_bf16 v[24:27], a[4:7], v[52:55], v[24:27]
    v_cvt_pk_bf16_f32 v84, v20, v21
    v_cvt_pk_bf16_f32 v85, v22, v23
    ds_write_b16 v9, v84 offset:1152
    ds_write_b16_d16_hi v9, v84 offset:1156
    ds_write_b16 v9, v85 offset:1160
    s_waitcnt lgkmcnt(13)
    ds_write_b16_d16_hi v9, v85 offset:1164
    v_mfma_f32_16x16x32_bf16 v[28:31], a[40:43], v[56:59], v[28:31]
    v_mfma_f32_16x16x32_bf16 v[24:27], a[8:11], v[56:59], v[24:27]
    s_waitcnt lgkmcnt(13)
    v_mfma_f32_16x16x32_bf16 v[28:31], a[44:47], v[60:63], v[28:31]
    ds_read_b128 v[52:55], v4 offset:64
    v_mfma_f32_16x16x32_bf16 v[24:27], a[12:15], v[60:63], v[24:27]
    s_waitcnt lgkmcnt(13)
    v_mfma_f32_16x16x32_bf16 v[28:31], a[48:51], v[64:67], v[28:31]
    s_mov_b32 s14, 655360
    buffer_load_dwordx4 v[40:43], v12, s[56:59], s14 offen
    ds_read_b128 v[56:59], v4 offset:128
    v_mfma_f32_16x16x32_bf16 v[24:27], a[16:19], v[64:67], v[24:27]
    s_waitcnt lgkmcnt(13)
    v_mfma_f32_16x16x32_bf16 v[28:31], a[52:55], v[68:71], v[28:31]
    ds_read_b128 v[60:63], v4 offset:192
    v_mfma_f32_16x16x32_bf16 v[24:27], a[20:23], v[68:71], v[24:27]
    s_waitcnt lgkmcnt(13)
    v_mfma_f32_16x16x32_bf16 v[28:31], a[56:59], v[72:75], v[28:31]
    ds_read_b128 v[64:67], v4 offset:256
    v_mfma_f32_16x16x32_bf16 v[24:27], a[24:27], v[72:75], v[24:27]
    s_waitcnt lgkmcnt(13)
    v_mfma_f32_16x16x32_bf16 v[28:31], a[60:63], v[76:79], v[28:31]
    ds_read_b128 v[68:71], v4 offset:320
    v_mfma_f32_16x16x32_bf16 v[24:27], a[28:31], v[76:79], v[24:27]
    s_waitcnt lgkmcnt(11)
    v_mfma_f32_16x16x32_bf16 v[28:31], a[0:3], v[48:51], v[28:31]
    s_mov_b32 s14, 983040
    buffer_load_dwordx4 v[44:47], v12, s[56:59], s14 offen
    ds_read_b128 v[72:75], v4 offset:384
    ds_read_b128 v[76:79], v4 offset:448
    s_waitcnt lgkmcnt(6)
    v_mfma_f32_16x16x32_bf16 v[28:31], a[4:7], v[52:55], v[28:31]
    ds_read_b128 v[48:51], v4 offset:22016
    ds_read2_b32 a[64:65], v7 offset0:128 offset1:129
    ds_read2_b32 a[66:67], v7 offset0:130 offset1:131
    s_waitcnt lgkmcnt(8)
    v_mfma_f32_16x16x32_bf16 v[28:31], a[8:11], v[56:59], v[28:31]
    ds_write_b16 v14, v3 offset:33824
    ds_write_b16 v14, v3 offset:35934
    ds_read2_b32 a[32:33], v7 offset0:0 offset1:1
    ds_read2_b32 a[34:35], v7 offset0:2 offset1:3
    s_waitcnt lgkmcnt(11)
    v_mfma_f32_16x16x32_bf16 v[28:31], a[12:15], v[60:63], v[28:31]
    v_cvt_pk_bf16_f32 v84, v24, v25
    v_cvt_pk_bf16_f32 v85, v26, v27
    ds_write_b16 v9, v84 offset:2304
    ds_write_b16_d16_hi v9, v84 offset:2308
    ds_write_b16 v9, v85 offset:2312
    s_waitcnt lgkmcnt(13)
    ds_write_b16_d16_hi v9, v85 offset:2316
    v_mfma_f32_16x16x32_bf16 v[28:31], a[16:19], v[64:67], v[28:31]
    s_waitcnt lgkmcnt(13)
    v_mfma_f32_16x16x32_bf16 v[28:31], a[20:23], v[68:71], v[28:31]
    ds_read_b128 v[52:55], v4 offset:22080
    s_waitcnt lgkmcnt(13)
    v_mfma_f32_16x16x32_bf16 v[28:31], a[24:27], v[72:75], v[28:31]
    ds_read_b128 v[56:59], v4 offset:22144
    s_waitcnt lgkmcnt(13)
    v_mfma_f32_16x16x32_bf16 v[28:31], a[28:31], v[76:79], v[28:31]
    s_nop 7
    v_cvt_pk_bf16_f32 v84, v28, v29
    v_cvt_pk_bf16_f32 v85, v30, v31
    ds_write_b16 v9, v84 offset:3456
    s_waitcnt lgkmcnt(13)
    ds_write_b16_d16_hi v9, v84 offset:3460
    s_waitcnt lgkmcnt(13)
    ds_write_b16 v9, v85 offset:3464
    s_waitcnt lgkmcnt(13)
    ds_write_b16_d16_hi v9, v85 offset:3468
    v_mfma_f32_16x16x32_bf16 v[28:31], a[128:131], v[48:51], 0
    v_mfma_f32_16x16x32_bf16 v[24:27], a[96:99], v[48:51], 0
    v_mfma_f32_16x16x32_bf16 v[20:23], a[64:67], v[48:51], 0
    s_waitcnt lgkmcnt(10)
    v_mfma_f32_16x16x32_bf16 v[16:19], a[32:35], v[48:51], 0
    ds_read2_b32 a[132:133], v8 offset0:144 offset1:145
    ds_read2_b32 a[134:135], v8 offset0:146 offset1:147
    ds_read2_b32 a[100:101], v8 offset0:16 offset1:17
    ds_read2_b32 a[102:103], v8 offset0:18 offset1:19
    s_waitcnt lgkmcnt(2)
    v_mfma_f32_16x16x32_bf16 v[28:31], a[132:135], v[52:55], v[28:31]
    ds_read2_b32 a[68:69], v7 offset0:144 offset1:145
    ds_read2_b32 a[70:71], v7 offset0:146 offset1:147
    ds_read2_b32 a[36:37], v7 offset0:16 offset1:17
    ds_read2_b32 a[38:39], v7 offset0:18 offset1:19
    s_waitcnt lgkmcnt(4)
    v_mfma_f32_16x16x32_bf16 v[24:27], a[100:103], v[52:55], v[24:27]
    ds_read2_b32 a[136:137], v8 offset0:160 offset1:161
    ds_read2_b32 a[138:139], v8 offset0:162 offset1:163
    ds_read2_b32 a[104:105], v8 offset0:32 offset1:33
    ds_read2_b32 a[106:107], v8 offset0:34 offset1:35
    s_waitcnt lgkmcnt(6)
    v_mfma_f32_16x16x32_bf16 v[20:23], a[68:71], v[52:55], v[20:23]
    ds_read2_b32 a[72:73], v7 offset0:160 offset1:161
    ds_read2_b32 a[74:75], v7 offset0:162 offset1:163
    ds_read2_b32 a[40:41], v7 offset0:32 offset1:33
    ds_read2_b32 a[42:43], v7 offset0:34 offset1:35
    s_waitcnt lgkmcnt(8)
    v_mfma_f32_16x16x32_bf16 v[16:19], a[36:39], v[52:55], v[16:19]
    ds_read_b128 v[60:63], v4 offset:22208
    ds_read2_b32 a[140:141], v8 offset0:176 offset1:177
    ds_read2_b32 a[142:143], v8 offset0:178 offset1:179
    ds_read2_b32 a[108:109], v8 offset0:48 offset1:49
    ds_read2_b32 a[110:111], v8 offset0:50 offset1:51
    s_waitcnt lgkmcnt(11)
    v_mfma_f32_16x16x32_bf16 v[28:31], a[136:139], v[56:59], v[28:31]
    ds_read2_b32 a[76:77], v7 offset0:176 offset1:177
    ds_read2_b32 a[78:79], v7 offset0:178 offset1:179
    ds_read_b128 v[64:67], v4 offset:22272
    s_waitcnt lgkmcnt(12)
    v_mfma_f32_16x16x32_bf16 v[24:27], a[104:107], v[56:59], v[24:27]
    ds_read2_b32 a[44:45], v7 offset0:48 offset1:49
    ds_read2_b32 a[46:47], v7 offset0:50 offset1:51
    s_waitcnt lgkmcnt(12)
    v_mfma_f32_16x16x32_bf16 v[20:23], a[72:75], v[56:59], v[20:23]
    ds_read2_b32 a[144:145], v8 offset0:192 offset1:193
    ds_read2_b32 a[146:147], v8 offset0:194 offset1:195
    s_waitcnt lgkmcnt(12)
    v_mfma_f32_16x16x32_bf16 v[16:19], a[40:43], v[56:59], v[16:19]
    ds_read2_b32 a[112:113], v8 offset0:64 offset1:65
    ds_read2_b32 a[114:115], v8 offset0:66 offset1:67
    s_waitcnt lgkmcnt(11)
    v_mfma_f32_16x16x32_bf16 v[28:31], a[140:143], v[60:63], v[28:31]
    ds_read2_b32 a[80:81], v7 offset0:192 offset1:193
    ds_read2_b32 a[82:83], v7 offset0:194 offset1:195
    ds_read_b128 v[68:71], v4 offset:22336
    s_waitcnt lgkmcnt(12)
    v_mfma_f32_16x16x32_bf16 v[24:27], a[108:111], v[60:63], v[24:27]
    ds_read2_b32 a[48:49], v7 offset0:64 offset1:65
    ds_read2_b32 a[50:51], v7 offset0:66 offset1:67
    s_waitcnt lgkmcnt(12)
    v_mfma_f32_16x16x32_bf16 v[20:23], a[76:79], v[60:63], v[20:23]
    ds_read2_b32 a[148:149], v8 offset0:208 offset1:209
    ds_read2_b32 a[150:151], v8 offset0:210 offset1:211
    s_waitcnt lgkmcnt(11)
    v_mfma_f32_16x16x32_bf16 v[16:19], a[44:47], v[60:63], v[16:19]
    ds_read2_b32 a[116:117], v8 offset0:80 offset1:81
    ds_read2_b32 a[118:119], v8 offset0:82 offset1:83
    ds_read_b128 v[72:75], v4 offset:22400
    s_waitcnt lgkmcnt(12)
    v_mfma_f32_16x16x32_bf16 v[28:31], a[144:147], v[64:67], v[28:31]
    ds_read2_b32 a[84:85], v7 offset0:208 offset1:209
    ds_read2_b32 a[86:87], v7 offset0:210 offset1:211
    s_waitcnt lgkmcnt(12)
    v_mfma_f32_16x16x32_bf16 v[24:27], a[112:115], v[64:67], v[24:27]
    ds_read2_b32 a[52:53], v7 offset0:80 offset1:81
    ds_read2_b32 a[54:55], v7 offset0:82 offset1:83
    s_waitcnt lgkmcnt(12)
    v_mfma_f32_16x16x32_bf16 v[20:23], a[80:83], v[64:67], v[20:23]
    ds_read2_b32 a[152:153], v8 offset0:224 offset1:225
    ds_read2_b32 a[154:155], v8 offset0:226 offset1:227
    s_waitcnt lgkmcnt(11)
    v_mfma_f32_16x16x32_bf16 v[16:19], a[48:51], v[64:67], v[16:19]
    ds_read2_b32 a[120:121], v8 offset0:96 offset1:97
    ds_read2_b32 a[122:123], v8 offset0:98 offset1:99
    ds_read_b128 v[76:79], v4 offset:22464
    s_waitcnt lgkmcnt(12)
    v_mfma_f32_16x16x32_bf16 v[28:31], a[148:151], v[68:71], v[28:31]
    ds_read2_b32 a[88:89], v7 offset0:224 offset1:225
    ds_read2_b32 a[90:91], v7 offset0:226 offset1:227
    s_waitcnt lgkmcnt(12)
    v_mfma_f32_16x16x32_bf16 v[24:27], a[116:119], v[68:71], v[24:27]
    ds_read2_b32 a[56:57], v7 offset0:96 offset1:97
    ds_read2_b32 a[58:59], v7 offset0:98 offset1:99
    s_waitcnt lgkmcnt(11)
    v_mfma_f32_16x16x32_bf16 v[20:23], a[84:87], v[68:71], v[20:23]
    ds_read2_b32 a[156:157], v8 offset0:240 offset1:241
    ds_read2_b32 a[158:159], v8 offset0:242 offset1:243
    ds_read_b128 v[48:51], v4 offset:21504
    s_waitcnt lgkmcnt(12)
    v_mfma_f32_16x16x32_bf16 v[16:19], a[52:55], v[68:71], v[16:19]
    ds_read2_b32 a[124:125], v8 offset0:112 offset1:113
    ds_read2_b32 a[126:127], v8 offset0:114 offset1:115
    s_waitcnt lgkmcnt(12)
    v_mfma_f32_16x16x32_bf16 v[28:31], a[152:155], v[72:75], v[28:31]
    ds_read2_b32 a[92:93], v7 offset0:240 offset1:241
    ds_read2_b32 a[94:95], v7 offset0:242 offset1:243
    s_waitcnt lgkmcnt(12)
    v_mfma_f32_16x16x32_bf16 v[24:27], a[120:123], v[72:75], v[24:27]
    ds_read2_b32 a[60:61], v7 offset0:112 offset1:113
    ds_read2_b32 a[62:63], v7 offset0:114 offset1:115
    s_waitcnt lgkmcnt(11)
    v_mfma_f32_16x16x32_bf16 v[20:23], a[88:91], v[72:75], v[20:23]
    ds_read_b128 v[52:55], v4 offset:21568
    ds_read_b128 v[56:59], v4 offset:21632
    ds_read_b128 v[60:63], v4 offset:21696
    s_waitcnt lgkmcnt(12)
    v_mfma_f32_16x16x32_bf16 v[16:19], a[56:59], v[72:75], v[16:19]
    ds_read_b128 v[64:67], v4 offset:21760
    ds_read_b128 v[68:71], v4 offset:21824
    s_waitcnt lgkmcnt(12)
    v_mfma_f32_16x16x32_bf16 v[28:31], a[156:159], v[76:79], v[28:31]
    ds_read_b128 v[72:75], v4 offset:21888
    s_waitcnt lgkmcnt(10)
    v_mfma_f32_16x16x32_bf16 v[24:27], a[124:127], v[76:79], v[24:27]
    s_waitcnt lgkmcnt(8)
    v_mfma_f32_16x16x32_bf16 v[20:23], a[92:95], v[76:79], v[20:23]
    s_waitcnt lgkmcnt(6)
    v_mfma_f32_16x16x32_bf16 v[16:19], a[60:63], v[76:79], v[16:19]
    ds_read_b128 v[76:79], v4 offset:21952
    v_mfma_f32_16x16x32_bf16 v[28:31], a[96:99], v[48:51], v[28:31]
    v_mfma_f32_16x16x32_bf16 v[24:27], a[64:67], v[48:51], v[24:27]
    v_mfma_f32_16x16x32_bf16 v[20:23], a[32:35], v[48:51], v[20:23]
    s_waitcnt vmcnt(4)
    ds_read_b128 v[48:51], v4 offset:20992
    s_waitcnt lgkmcnt(7)
    v_mfma_f32_16x16x32_bf16 v[28:31], a[100:103], v[52:55], v[28:31]
    v_cvt_pk_bf16_f32 v84, v16, v17
    v_cvt_pk_bf16_f32 v85, v18, v19
    ds_write_b16 v9, v84 offset:2
    ds_write_b16_d16_hi v9, v84 offset:6
    ds_write_b16 v9, v85 offset:10
    ds_write_b16_d16_hi v9, v85 offset:14
    v_mfma_f32_16x16x32_bf16 v[24:27], a[68:71], v[52:55], v[24:27]
    v_mfma_f32_16x16x32_bf16 v[20:23], a[36:39], v[52:55], v[20:23]
    ds_read_b128 v[52:55], v4 offset:21056
    s_waitcnt lgkmcnt(11)
    v_mfma_f32_16x16x32_bf16 v[28:31], a[104:107], v[56:59], v[28:31]
    v_mfma_f32_16x16x32_bf16 v[24:27], a[72:75], v[56:59], v[24:27]
    v_mfma_f32_16x16x32_bf16 v[20:23], a[40:43], v[56:59], v[20:23]
    s_waitcnt lgkmcnt(1)
    s_barrier
    ds_read_b64_tr_b16 v[88:89], v10 offset:0
    ds_read_b64_tr_b16 v[90:91], v10 offset:18688
    ds_read_b128 v[56:59], v4 offset:21120
    v_mfma_f32_16x16x32_bf16 v[28:31], a[108:111], v[60:63], v[28:31]
    v_mfma_f32_16x16x32_bf16 v[24:27], a[76:79], v[60:63], v[24:27]
    v_mfma_f32_16x16x32_bf16 v[20:23], a[44:47], v[60:63], v[20:23]
    ds_read_b128 v[60:63], v4 offset:21184
    v_mfma_f32_16x16x32_bf16 v[28:31], a[112:115], v[64:67], v[28:31]
    s_waitcnt vmcnt(3)
    s_waitcnt lgkmcnt(2)
    v_and_or_b32 v92, v32, v86, s67
    v_and_or_b32 v93, v32, v87, s69
    v_mfma_f32_16x16x32_bf16 v[24:27], a[80:83], v[64:67], v[24:27]
    v_and_or_b32 v94, v33, v86, s67
    v_and_or_b32 v95, v33, v87, s69
    v_dot2_f32_bf16 v92, v88, v92, 0
    v_mfma_f32_16x16x32_bf16 v[20:23], a[48:51], v[64:67], v[20:23]
    ds_read_b128 v[64:67], v4 offset:21248
    v_dot2_f32_bf16 v93, v88, v93, 0
    v_dot2_f32_bf16 v94, v89, v94, 0
    v_dot2_f32_bf16 v95, v89, v95, 0
    v_mfma_f32_16x16x32_bf16 v[28:31], a[116:119], v[68:71], v[28:31]
    s_nop 1
    v_cvt_pk_bf16_f32 v88, v92, v93
    v_cvt_pk_bf16_f32 v89, v94, v95
    v_mfma_f32_16x16x32_bf16 v[24:27], a[84:87], v[68:71], v[24:27]
    v_and_or_b32 v92, v34, v86, s67
    v_and_or_b32 v93, v34, v87, s69
    v_and_or_b32 v94, v35, v86, s67
    v_mfma_f32_16x16x32_bf16 v[20:23], a[52:55], v[68:71], v[20:23]
    ds_read_b128 v[68:71], v4 offset:21312
    v_and_or_b32 v95, v35, v87, s69
    v_dot2_f32_bf16 v92, v90, v92, 0
    v_dot2_f32_bf16 v93, v90, v93, 0
    v_mfma_f32_16x16x32_bf16 v[28:31], a[120:123], v[72:75], v[28:31]
    v_dot2_f32_bf16 v94, v91, v94, 0
    v_dot2_f32_bf16 v95, v91, v95, 0
    s_nop 1
    v_mfma_f32_16x16x32_bf16 v[24:27], a[88:91], v[72:75], v[24:27]
    v_cvt_pk_bf16_f32 v90, v92, v93
    v_cvt_pk_bf16_f32 v91, v94, v95
    s_mov_b32 s68, 0
    buffer_store_dwordx4 v[88:91], v11, s[60:63], s68 offen
    v_mfma_f32_16x16x32_bf16 v[20:23], a[56:59], v[72:75], v[20:23]
    ds_read_b128 v[72:75], v4 offset:21376
    v_mfma_f32_16x16x32_bf16 v[28:31], a[124:127], v[76:79], v[28:31]
    v_mfma_f32_16x16x32_bf16 v[24:27], a[92:95], v[76:79], v[24:27]
    v_mfma_f32_16x16x32_bf16 v[20:23], a[60:63], v[76:79], v[20:23]
    ds_read_b128 v[76:79], v4 offset:21440
    v_mfma_f32_16x16x32_bf16 v[28:31], a[64:67], v[48:51], v[28:31]
    v_mfma_f32_16x16x32_bf16 v[24:27], a[32:35], v[48:51], v[24:27]
    ds_read_b128 v[48:51], v4 offset:20480
    v_mfma_f32_16x16x32_bf16 v[28:31], a[68:71], v[52:55], v[28:31]
    v_mfma_f32_16x16x32_bf16 v[24:27], a[36:39], v[52:55], v[24:27]
    s_nop 1
    v_cvt_pk_bf16_f32 v84, v20, v21
    v_cvt_pk_bf16_f32 v85, v22, v23
    ds_write_b16 v9, v84 offset:1154
    ds_write_b16_d16_hi v9, v84 offset:1158
    ds_write_b16 v9, v85 offset:1162
    ds_write_b16_d16_hi v9, v85 offset:1166
    ds_read_b128 v[52:55], v4 offset:20544
    s_waitcnt lgkmcnt(11)
    v_mfma_f32_16x16x32_bf16 v[28:31], a[72:75], v[56:59], v[28:31]
    v_mfma_f32_16x16x32_bf16 v[24:27], a[40:43], v[56:59], v[24:27]
    ds_read_b128 v[56:59], v4 offset:20608
    s_waitcnt lgkmcnt(11)
    v_mfma_f32_16x16x32_bf16 v[28:31], a[76:79], v[60:63], v[28:31]
    v_mfma_f32_16x16x32_bf16 v[24:27], a[44:47], v[60:63], v[24:27]
    ds_read_b128 v[60:63], v4 offset:20672
    s_waitcnt lgkmcnt(11)
    v_mfma_f32_16x16x32_bf16 v[28:31], a[80:83], v[64:67], v[28:31]
    s_waitcnt lgkmcnt(3)
    s_barrier
    ds_read_b64_tr_b16 v[88:89], v10 offset:1152
    ds_read_b64_tr_b16 v[90:91], v10 offset:19840
    v_mfma_f32_16x16x32_bf16 v[24:27], a[48:51], v[64:67], v[24:27]
    ds_read_b128 v[64:67], v4 offset:20736
    v_mfma_f32_16x16x32_bf16 v[28:31], a[84:87], v[68:71], v[28:31]
    v_mfma_f32_16x16x32_bf16 v[24:27], a[52:55], v[68:71], v[24:27]
    ds_read_b128 v[68:71], v4 offset:20800
    v_mfma_f32_16x16x32_bf16 v[28:31], a[88:91], v[72:75], v[28:31]
    s_waitcnt vmcnt(3)
    s_waitcnt lgkmcnt(2)
    v_and_or_b32 v92, v36, v86, s67
    v_and_or_b32 v93, v36, v87, s69
    v_mfma_f32_16x16x32_bf16 v[24:27], a[56:59], v[72:75], v[24:27]
    ds_read_b128 v[72:75], v4 offset:20864
    v_and_or_b32 v94, v37, v86, s67
    v_and_or_b32 v95, v37, v87, s69
    v_dot2_f32_bf16 v92, v88, v92, 0
    v_mfma_f32_16x16x32_bf16 v[28:31], a[92:95], v[76:79], v[28:31]
    v_dot2_f32_bf16 v93, v88, v93, 0
    v_dot2_f32_bf16 v94, v89, v94, 0
    v_dot2_f32_bf16 v95, v89, v95, 0
    v_mfma_f32_16x16x32_bf16 v[24:27], a[60:63], v[76:79], v[24:27]
    ds_read_b128 v[76:79], v4 offset:20928
    s_nop 1
    v_cvt_pk_bf16_f32 v88, v92, v93
    v_cvt_pk_bf16_f32 v89, v94, v95
    v_mfma_f32_16x16x32_bf16 v[28:31], a[32:35], v[48:51], v[28:31]
    v_and_or_b32 v92, v38, v86, s67
    v_and_or_b32 v93, v38, v87, s69
    v_and_or_b32 v94, v39, v86, s67
    v_mfma_f32_16x16x32_bf16 v[28:31], a[36:39], v[52:55], v[28:31]
    v_and_or_b32 v95, v39, v87, s69
    v_dot2_f32_bf16 v92, v90, v92, 0
    v_dot2_f32_bf16 v93, v90, v93, 0
    v_mfma_f32_16x16x32_bf16 v[28:31], a[40:43], v[56:59], v[28:31]
    v_dot2_f32_bf16 v94, v91, v94, 0
    v_dot2_f32_bf16 v95, v91, v95, 0
    s_nop 1
    v_mfma_f32_16x16x32_bf16 v[28:31], a[44:47], v[60:63], v[28:31]
    v_cvt_pk_bf16_f32 v84, v24, v25
    v_cvt_pk_bf16_f32 v85, v26, v27
    ds_write_b16 v9, v84 offset:2306
    ds_write_b16_d16_hi v9, v84 offset:2310
    ds_write_b16 v9, v85 offset:2314
    ds_write_b16_d16_hi v9, v85 offset:2318
    v_cvt_pk_bf16_f32 v90, v92, v93
    v_cvt_pk_bf16_f32 v91, v94, v95
    s_mov_b32 s68, 655360
    buffer_store_dwordx4 v[88:91], v11, s[60:63], s68 offen
    s_waitcnt lgkmcnt(7)
    v_mfma_f32_16x16x32_bf16 v[28:31], a[48:51], v[64:67], v[28:31]
    s_waitcnt lgkmcnt(6)
    v_mfma_f32_16x16x32_bf16 v[28:31], a[52:55], v[68:71], v[28:31]
    s_waitcnt lgkmcnt(5)
    v_mfma_f32_16x16x32_bf16 v[28:31], a[56:59], v[72:75], v[28:31]
    s_waitcnt lgkmcnt(4)
    v_mfma_f32_16x16x32_bf16 v[28:31], a[60:63], v[76:79], v[28:31]
    s_nop 7
    v_cvt_pk_bf16_f32 v84, v28, v29
    v_cvt_pk_bf16_f32 v85, v30, v31
    ds_write_b16 v9, v84 offset:3458
    ds_write_b16_d16_hi v9, v84 offset:3462
    ds_write_b16 v9, v85 offset:3466
    ds_write_b16_d16_hi v9, v85 offset:3470
    s_waitcnt lgkmcnt(4)
    s_barrier
    ds_read_b64_tr_b16 v[88:89], v10 offset:2304
    ds_read_b64_tr_b16 v[90:91], v10 offset:20992
    s_waitcnt vmcnt(3)
    s_waitcnt lgkmcnt(0)
    v_and_or_b32 v92, v40, v86, s67
    v_and_or_b32 v93, v40, v87, s69
    v_and_or_b32 v94, v41, v86, s67
    v_and_or_b32 v95, v41, v87, s69
    v_dot2_f32_bf16 v92, v88, v92, 0
    v_dot2_f32_bf16 v93, v88, v93, 0
    v_dot2_f32_bf16 v94, v89, v94, 0
    v_dot2_f32_bf16 v95, v89, v95, 0
    s_nop 1
    v_cvt_pk_bf16_f32 v88, v92, v93
    v_cvt_pk_bf16_f32 v89, v94, v95
    v_and_or_b32 v92, v42, v86, s67
    v_and_or_b32 v93, v42, v87, s69
    v_and_or_b32 v94, v43, v86, s67
    v_and_or_b32 v95, v43, v87, s69
    v_dot2_f32_bf16 v92, v90, v92, 0
    v_dot2_f32_bf16 v93, v90, v93, 0
    v_dot2_f32_bf16 v94, v91, v94, 0
    v_dot2_f32_bf16 v95, v91, v95, 0
    s_nop 1
    v_cvt_pk_bf16_f32 v90, v92, v93
    v_cvt_pk_bf16_f32 v91, v94, v95
    s_mov_b32 s68, 1310720
    buffer_store_dwordx4 v[88:91], v11, s[60:63], s68 offen
    s_barrier
    ds_read_b64_tr_b16 v[88:89], v10 offset:3456
    ds_read_b64_tr_b16 v[90:91], v10 offset:22144
    s_waitcnt vmcnt(3)
    s_waitcnt lgkmcnt(0)
    v_and_or_b32 v92, v44, v86, s67
    v_and_or_b32 v93, v44, v87, s69
    v_and_or_b32 v94, v45, v86, s67
    v_and_or_b32 v95, v45, v87, s69
    v_dot2_f32_bf16 v92, v88, v92, 0
    v_dot2_f32_bf16 v93, v88, v93, 0
    v_dot2_f32_bf16 v94, v89, v94, 0
    v_dot2_f32_bf16 v95, v89, v95, 0
    s_nop 1
    v_cvt_pk_bf16_f32 v88, v92, v93
    v_cvt_pk_bf16_f32 v89, v94, v95
    v_and_or_b32 v92, v46, v86, s67
    v_and_or_b32 v93, v46, v87, s69
    v_and_or_b32 v94, v47, v86, s67
    v_and_or_b32 v95, v47, v87, s69
    v_dot2_f32_bf16 v92, v90, v92, 0
    v_dot2_f32_bf16 v93, v90, v93, 0
    v_dot2_f32_bf16 v94, v91, v94, 0
    v_dot2_f32_bf16 v95, v91, v95, 0
    s_nop 1
    v_cvt_pk_bf16_f32 v90, v92, v93
    v_cvt_pk_bf16_f32 v91, v94, v95
    s_mov_b32 s68, 1966080
    buffer_store_dwordx4 v[88:91], v11, s[60:63], s68 offen
    s_endpgm
L_T2_Y:
    s_barrier
    s_add_u32 s15, s13, 0
    s_add_u32 m0, s70, 0
    s_nop 0
    buffer_load_dwordx4 v13, s[48:51], s15 offen offset:1024 lds
    s_add_u32 s15, s10, 0
    s_add_u32 m0, s71, 32
    s_nop 0
    buffer_load_dwordx4 v13, s[52:55], s15 offen offset:1024 lds
    s_add_u32 s15, s10, 2
    s_add_u32 m0, s71, 2144
    s_nop 0
    buffer_load_dwordx4 v13, s[52:55], s15 offen offset:1024 lds
    s_add_u32 s15, s10, 0
    s_add_u32 m0, s71, 32
    s_nop 0
    buffer_load_dwordx4 v13, s[52:55], s15 offen offset:0 lds
    s_add_u32 s15, s10, 2
    s_add_u32 m0, s71, 2144
    s_nop 0
    buffer_load_dwordx4 v13, s[52:55], s15 offen offset:0 lds
    s_cmp_lg_u32 s3, 7
    s_cbranch_scc1 L_nocp_15
    s_getpc_b64 s[82:83]
L_pc_16:
    v_lshlrev_b32 v94, 7, v1
    v_min_u32 v94, L_end_T2-L_pc_16-4, v94
    global_load_dword v95, v94, s[82:83]
L_nocp_15:
    s_waitcnt vmcnt(4)
    ds_read_b128 v[48:51], v4 offset:1536
    s_waitcnt vmcnt(2)
    ds_read2_b32 a[96:97], v6 offset0:128 offset1:129
    ds_read2_b32 a[98:99], v6 offset0:130 offset1:131
    ds_read_b128 v[52:55], v4 offset:1600
    ds_read2_b32 a[100:101], v6 offset0:144 offset1:145
    ds_read2_b32 a[102:103], v6 offset0:146 offset1:147
    ds_read_b128 v[56:59], v4 offset:1664
    s_waitcnt lgkmcnt(4)
    v_mfma_f32_16x16x32_bf16 v[28:31], a[96:99], v[48:51], 0
    s_add_u32 s15, s13, 0
    s_add_u32 m0, s70, 0
    s_nop 0
    buffer_load_dwordx4 v13, s[48:51], s15 offen offset:0 lds
    ds_read2_b32 a[104:105], v6 offset0:160 offset1:161
    ds_read2_b32 a[106:107], v6 offset0:162 offset1:163
    ds_read_b128 v[60:63], v4 offset:1728
    ds_read2_b32 a[108:109], v6 offset0:176 offset1:177
    ds_read2_b32 a[110:111], v6 offset0:178 offset1:179
    s_waitcnt lgkmcnt(6)
    v_mfma_f32_16x16x32_bf16 v[28:31], a[100:103], v[52:55], v[28:31]
    ds_read_b128 v[64:67], v4 offset:1792
    ds_read2_b32 a[112:113], v6 offset0:192 offset1:193
    ds_read2_b32 a[114:115], v6 offset0:194 offset1:195
    ds_read_b128 v[68:71], v4 offset:1856
    s_waitcnt lgkmcnt(7)
    v_mfma_f32_16x16x32_bf16 v[28:31], a[104:107], v[56:59], v[28:31]
    ds_read2_b32 a[116:117], v6 offset0:208 offset1:209
    ds_read2_b32 a[118:119], v6 offset0:210 offset1:211
    ds_read_b128 v[72:75], v4 offset:1920
    ds_read2_b32 a[120:121], v6 offset0:224 offset1:225
    ds_read2_b32 a[122:123], v6 offset0:226 offset1:227
    s_waitcnt lgkmcnt(9)
    v_mfma_f32_16x16x32_bf16 v[28:31], a[108:111], v[60:63], v[28:31]
    ds_read_b128 v[76:79], v4 offset:1984
    ds_read2_b32 a[124:125], v6 offset0:240 offset1:241
    ds_read2_b32 a[126:127], v6 offset0:242 offset1:243
    s_waitcnt vmcnt(1)
    ds_read2_b32 a[64:65], v6 offset0:0 offset1:1
    ds_read2_b32 a[66:67], v6 offset0:2 offset1:3
    s_waitcnt lgkmcnt(11)
    v_mfma_f32_16x16x32_bf16 v[28:31], a[112:115], v[64:67], v[28:31]
    ds_read2_b32 a[68:69], v6 offset0:16 offset1:17
    ds_read2_b32 a[70:71], v6 offset0:18 offset1:19
    s_waitcnt lgkmcnt(10)
    v_mfma_f32_16x16x32_bf16 v[28:31], a[116:119], v[68:71], v[28:31]
    ds_read2_b32 a[72:73], v6 offset0:32 offset1:33
    ds_read2_b32 a[74:75], v6 offset0:34 offset1:35
    ds_read2_b32 a[76:77], v6 offset0:48 offset1:49
    ds_read2_b32 a[78:79], v6 offset0:50 offset1:51
    s_waitcnt lgkmcnt(11)
    v_mfma_f32_16x16x32_bf16 v[28:31], a[120:123], v[72:75], v[28:31]
    ds_read2_b32 a[80:81], v6 offset0:64 offset1:65
    ds_read2_b32 a[82:83], v6 offset0:66 offset1:67
    s_waitcnt lgkmcnt(10)
    v_mfma_f32_16x16x32_bf16 v[28:31], a[124:127], v[76:79], v[28:31]
    ds_read2_b32 a[84:85], v6 offset0:80 offset1:81
    ds_read2_b32 a[86:87], v6 offset0:82 offset1:83
    ds_read2_b32 a[88:89], v6 offset0:96 offset1:97
    ds_read2_b32 a[90:91], v6 offset0:98 offset1:99
    s_waitcnt lgkmcnt(12)
    v_mfma_f32_16x16x32_bf16 v[24:27], a[64:67], v[48:51], 0
    ds_read2_b32 a[92:93], v6 offset0:112 offset1:113
    ds_read2_b32 a[94:95], v6 offset0:114 offset1:115
    s_waitcnt lgkmcnt(12)
    v_mfma_f32_16x16x32_bf16 v[24:27], a[68:71], v[52:55], v[24:27]
    ds_read2_b32 a[32:33], v5 offset0:128 offset1:129
    ds_read2_b32 a[34:35], v5 offset0:130 offset1:131
    s_waitcnt lgkmcnt(12)
    v_mfma_f32_16x16x32_bf16 v[24:27], a[72:75], v[56:59], v[24:27]
    ds_read2_b32 a[36:37], v5 offset0:144 offset1:145
    ds_read2_b32 a[38:39], v5 offset0:146 offset1:147
    s_waitcnt lgkmcnt(12)
    v_mfma_f32_16x16x32_bf16 v[24:27], a[76:79], v[60:63], v[24:27]
    s_add_u32 s15, s13, 32768
    s_add_u32 m0, s70, 20480
    s_nop 0
    buffer_load_dwordx4 v13, s[48:51], s15 offen offset:1024 lds
    ds_read2_b32 a[40:41], v5 offset0:160 offset1:161
    ds_read2_b32 a[42:43], v5 offset0:162 offset1:163
    s_waitcnt lgkmcnt(12)
    v_mfma_f32_16x16x32_bf16 v[24:27], a[80:83], v[64:67], v[24:27]
    ds_read2_b32 a[44:45], v5 offset0:176 offset1:177
    ds_read2_b32 a[46:47], v5 offset0:178 offset1:179
    s_waitcnt lgkmcnt(12)
    v_mfma_f32_16x16x32_bf16 v[24:27], a[84:87], v[68:71], v[24:27]
    ds_read2_b32 a[48:49], v5 offset0:192 offset1:193
    ds_read2_b32 a[50:51], v5 offset0:194 offset1:195
    s_waitcnt lgkmcnt(12)
    v_mfma_f32_16x16x32_bf16 v[24:27], a[88:91], v[72:75], v[24:27]
    ds_read2_b32 a[52:53], v5 offset0:208 offset1:209
    ds_read2_b32 a[54:55], v5 offset0:210 offset1:211
    s_waitcnt lgkmcnt(12)
    v_mfma_f32_16x16x32_bf16 v[24:27], a[92:95], v[76:79], v[24:27]
    ds_read2_b32 a[56:57], v5 offset0:224 offset1:225
    ds_read2_b32 a[58:59], v5 offset0:226 offset1:227
    s_waitcnt lgkmcnt(12)
    v_mfma_f32_16x16x32_bf16 v[20:23], a[32:35], v[48:51], 0
    s_add_u32 s15, s10, 32768
    s_add_u32 m0, s71, 33824
    s_nop 0
    buffer_load_dwordx4 v13, s[52:55], s15 offen offset:1024 lds
    ds_read2_b32 a[60:61], v5 offset0:240 offset1:241
    ds_read2_b32 a[62:63], v5 offset0:242 offset1:243
    s_waitcnt lgkmcnt(12)
    v_mfma_f32_16x16x32_bf16 v[20:23], a[36:39], v[52:55], v[20:23]
    s_waitcnt lgkmcnt(0)
    s_and_b32 s14, s8, 1
    s_lshl_b32 s14, s14, 4
    s_lshl_b32 s72, s72, 16
    s_lshr_b32 s76, s76, s14
    s_lshl_b32 s76, s76, 16
    s_lshl_b32 s73, s73, 16
    s_lshr_b32 s77, s77, s14
    s_lshl_b32 s77, s77, 16
    s_cmp_eq_u32 s4, 1
    s_cselect_b32 s76, s76, 0
    s_cselect_b32 s77, s77, 0
    v_mov_b32 v2, s72
    v_add_f32 v2, s76, v2
    v_cvt_pk_bf16_f32 v2, v2, v2
    v_mov_b32 v3, s73
    v_add_f32 v3, s77, v3
    v_cvt_pk_bf16_f32 v3, v3, v3
    ds_write_b16 v14, v2 offset:32
    ds_write_b16 v14, v2 offset:2142
    ds_read2_b32 a[0:1], v5 offset0:0 offset1:1
    ds_read2_b32 a[2:3], v5 offset0:2 offset1:3
    ds_read2_b32 a[4:5], v5 offset0:16 offset1:17
    ds_read2_b32 a[6:7], v5 offset0:18 offset1:19
    v_mfma_f32_16x16x32_bf16 v[20:23], a[40:43], v[56:59], v[20:23]
    ds_read2_b32 a[8:9], v5 offset0:32 offset1:33
    ds_read2_b32 a[10:11], v5 offset0:34 offset1:35
    ds_read2_b32 a[12:13], v5 offset0:48 offset1:49
    ds_read2_b32 a[14:15], v5 offset0:50 offset1:51
    v_mfma_f32_16x16x32_bf16 v[20:23], a[44:47], v[60:63], v[20:23]
    ds_read2_b32 a[16:17], v5 offset0:64 offset1:65
    ds_read2_b32 a[18:19], v5 offset0:66 offset1:67
    ds_read2_b32 a[20:21], v5 offset0:80 offset1:81
    ds_read2_b32 a[22:23], v5 offset0:82 offset1:83
    v_mfma_f32_16x16x32_bf16 v[20:23], a[48:51], v[64:67], v[20:23]
    v_mfma_f32_16x16x32_bf16 v[20:23], a[52:55], v[68:71], v[20:23]
    s_add_u32 s15, s10, 32770
    s_add_u32 m0, s71, 35936
    s_nop 0
    buffer_load_dwordx4 v13, s[52:55], s15 offen offset:1024 lds
    v_mfma_f32_16x16x32_bf16 v[20:23], a[56:59], v[72:75], v[20:23]
    v_mfma_f32_16x16x32_bf16 v[20:23], a[60:63], v[76:79], v[20:23]
    s_waitcnt lgkmcnt(10)
    v_mfma_f32_16x16x32_bf16 v[16:19], a[0:3], v[48:51], 0
    ds_read2_b32 a[24:25], v5 offset0:96 offset1:97
    ds_read2_b32 a[26:27], v5 offset0:98 offset1:99
    ds_read2_b32 a[28:29], v5 offset0:112 offset1:113
    ds_read2_b32 a[30:31], v5 offset0:114 offset1:115
    s_waitcnt lgkmcnt(12)
    v_mfma_f32_16x16x32_bf16 v[16:19], a[4:7], v[52:55], v[16:19]
    ds_read_b128 v[48:51], v4 offset:1024
    ds_read_b128 v[52:55], v4 offset:1088
    s_waitcnt lgkmcnt(12)
    v_mfma_f32_16x16x32_bf16 v[16:19], a[8:11], v[56:59], v[16:19]
    s_add_u32 s15, s10, 32768
    s_add_u32 m0, s71, 33824
    s_nop 0
    buffer_load_dwordx4 v13, s[52:55], s15 offen offset:0 lds
    ds_read_b128 v[56:59], v4 offset:1152
    s_waitcnt lgkmcnt(11)
    v_mfma_f32_16x16x32_bf16 v[16:19], a[12:15], v[60:63], v[16:19]
    ds_read_b128 v[60:63], v4 offset:1216
    s_waitcnt lgkmcnt(10)
    v_mfma_f32_16x16x32_bf16 v[16:19], a[16:19], v[64:67], v[16:19]
    ds_read_b128 v[64:67], v4 offset:1280
    s_waitcnt lgkmcnt(9)
    v_mfma_f32_16x16x32_bf16 v[16:19], a[20:23], v[68:71], v[16:19]
    ds_read_b128 v[68:71], v4 offset:1344
    s_waitcnt lgkmcnt(8)
    v_mfma_f32_16x16x32_bf16 v[16:19], a[24:27], v[72:75], v[16:19]
    ds_read_b128 v[72:75], v4 offset:1408
    s_waitcnt lgkmcnt(7)
    v_mfma_f32_16x16x32_bf16 v[16:19], a[28:31], v[76:79], v[16:19]
    s_add_u32 s15, s10, 32770
    s_add_u32 m0, s71, 35936
    s_nop 0
    buffer_load_dwordx4 v13, s[52:55], s15 offen offset:0 lds
    ds_read_b128 v[76:79], v4 offset:1472
    s_waitcnt lgkmcnt(7)
    v_mfma_f32_16x16x32_bf16 v[28:31], a[64:67], v[48:51], v[28:31]
    v_mfma_f32_16x16x32_bf16 v[24:27], a[32:35], v[48:51], v[24:27]
    v_mfma_f32_16x16x32_bf16 v[20:23], a[0:3], v[48:51], v[20:23]
    s_waitcnt vmcnt(5)
    ds_read_b128 v[48:51], v4 offset:512
    s_waitcnt lgkmcnt(7)
    v_mfma_f32_16x16x32_bf16 v[28:31], a[68:71], v[52:55], v[28:31]
    v_cvt_pk_bf16_f32 v84, v16, v17
    v_cvt_pk_bf16_f32 v85, v18, v19
    ds_write_b16 v9, v84 offset:0
    ds_write_b16_d16_hi v9, v84 offset:4
    ds_write_b16 v9, v85 offset:8
    ds_write_b16_d16_hi v9, v85 offset:12
    v_mfma_f32_16x16x32_bf16 v[24:27], a[36:39], v[52:55], v[24:27]
    s_add_u32 s15, s13, 32768
    s_add_u32 m0, s70, 20480
    s_nop 0
    buffer_load_dwordx4 v13, s[48:51], s15 offen offset:0 lds
    v_mfma_f32_16x16x32_bf16 v[20:23], a[4:7], v[52:55], v[20:23]
    ds_read_b128 v[52:55], v4 offset:576
    s_waitcnt lgkmcnt(11)
    v_mfma_f32_16x16x32_bf16 v[28:31], a[72:75], v[56:59], v[28:31]
    v_mfma_f32_16x16x32_bf16 v[24:27], a[40:43], v[56:59], v[24:27]
    v_mfma_f32_16x16x32_bf16 v[20:23], a[8:11], v[56:59], v[20:23]
    ds_read_b128 v[56:59], v4 offset:640
    s_waitcnt lgkmcnt(11)
    v_mfma_f32_16x16x32_bf16 v[28:31], a[76:79], v[60:63], v[28:31]
    v_mfma_f32_16x16x32_bf16 v[24:27], a[44:47], v[60:63], v[24:27]
    v_mfma_f32_16x16x32_bf16 v[20:23], a[12:15], v[60:63], v[20:23]
    ds_read_b128 v[60:63], v4 offset:704
    s_waitcnt lgkmcnt(11)
    v_mfma_f32_16x16x32_bf16 v[28:31], a[80:83], v[64:67], v[28:31]
    v_mfma_f32_16x16x32_bf16 v[24:27], a[48:51], v[64:67], v[24:27]
    v_mfma_f32_16x16x32_bf16 v[20:23], a[16:19], v[64:67], v[20:23]
    ds_read_b128 v[64:67], v4 offset:768
    s_waitcnt lgkmcnt(11)
    v_mfma_f32_16x16x32_bf16 v[28:31], a[84:87], v[68:71], v[28:31]
    v_mfma_f32_16x16x32_bf16 v[24:27], a[52:55], v[68:71], v[24:27]
    s_mov_b32 s14, 0
    buffer_load_dwordx4 v[32:35], v12, s[56:59], s14 offen
    v_mfma_f32_16x16x32_bf16 v[20:23], a[20:23], v[68:71], v[20:23]
    ds_read_b128 v[68:71], v4 offset:832
    s_waitcnt lgkmcnt(11)
    v_mfma_f32_16x16x32_bf16 v[28:31], a[88:91], v[72:75], v[28:31]
    v_mfma_f32_16x16x32_bf16 v[24:27], a[56:59], v[72:75], v[24:27]
    v_mfma_f32_16x16x32_bf16 v[20:23], a[24:27], v[72:75], v[20:23]
    ds_read_b128 v[72:75], v4 offset:896
    s_waitcnt lgkmcnt(11)
    v_mfma_f32_16x16x32_bf16 v[28:31], a[92:95], v[76:79], v[28:31]
    v_mfma_f32_16x16x32_bf16 v[24:27], a[60:63], v[76:79], v[24:27]
    v_mfma_f32_16x16x32_bf16 v[20:23], a[28:31], v[76:79], v[20:23]
    ds_read_b128 v[76:79], v4 offset:960
    s_waitcnt lgkmcnt(11)
    v_mfma_f32_16x16x32_bf16 v[28:31], a[32:35], v[48:51], v[28:31]
    s_mov_b32 s14, 327680
    buffer_load_dwordx4 v[36:39], v12, s[56:59], s14 offen
    s_waitcnt vmcnt(5)
    ds_read2_b32 a[128:129], v8 offset0:128 offset1:129
    ds_read2_b32 a[130:131], v8 offset0:130 offset1:131
    v_mfma_f32_16x16x32_bf16 v[24:27], a[0:3], v[48:51], v[24:27]
    ds_read_b128 v[48:51], v4 offset:0
    s_waitcnt lgkmcnt(9)
    v_mfma_f32_16x16x32_bf16 v[28:31], a[36:39], v[52:55], v[28:31]
    s_waitcnt vmcnt(3)
    ds_read2_b32 a[96:97], v8 offset0:0 offset1:1
    ds_read2_b32 a[98:99], v8 offset0:2 offset1:3
    v_mfma_f32_16x16x32_bf16 v[24:27], a[4:7], v[52:55], v[24:27]
    v_cvt_pk_bf16_f32 v84, v20, v21
    v_cvt_pk_bf16_f32 v85, v22, v23
    ds_write_b16 v9, v84 offset:1152
    ds_write_b16_d16_hi v9, v84 offset:1156
    ds_write_b16 v9, v85 offset:1160
    s_waitcnt lgkmcnt(13)
    ds_write_b16_d16_hi v9, v85 offset:1164
    v_mfma_f32_16x16x32_bf16 v[28:31], a[40:43], v[56:59], v[28:31]
    v_mfma_f32_16x16x32_bf16 v[24:27], a[8:11], v[56:59], v[24:27]
    s_waitcnt lgkmcnt(13)
    v_mfma_f32_16x16x32_bf16 v[28:31], a[44:47], v[60:63], v[28:31]
    ds_read_b128 v[52:55], v4 offset:64
    v_mfma_f32_16x16x32_bf16 v[24:27], a[12:15], v[60:63], v[24:27]
    s_waitcnt lgkmcnt(13)
    v_mfma_f32_16x16x32_bf16 v[28:31], a[48:51], v[64:67], v[28:31]
    s_mov_b32 s14, 655360
    buffer_load_dwordx4 v[40:43], v12, s[56:59], s14 offen
    ds_read_b128 v[56:59], v4 offset:128
    v_mfma_f32_16x16x32_bf16 v[24:27], a[16:19], v[64:67], v[24:27]
    s_waitcnt lgkmcnt(13)
    v_mfma_f32_16x16x32_bf16 v[28:31], a[52:55], v[68:71], v[28:31]
    ds_read_b128 v[60:63], v4 offset:192
    v_mfma_f32_16x16x32_bf16 v[24:27], a[20:23], v[68:71], v[24:27]
    s_waitcnt lgkmcnt(13)
    v_mfma_f32_16x16x32_bf16 v[28:31], a[56:59], v[72:75], v[28:31]
    ds_read_b128 v[64:67], v4 offset:256
    v_mfma_f32_16x16x32_bf16 v[24:27], a[24:27], v[72:75], v[24:27]
    s_waitcnt lgkmcnt(13)
    v_mfma_f32_16x16x32_bf16 v[28:31], a[60:63], v[76:79], v[28:31]
    ds_read_b128 v[68:71], v4 offset:320
    v_mfma_f32_16x16x32_bf16 v[24:27], a[28:31], v[76:79], v[24:27]
    s_waitcnt lgkmcnt(11)
    v_mfma_f32_16x16x32_bf16 v[28:31], a[0:3], v[48:51], v[28:31]
    s_mov_b32 s14, 983040
    buffer_load_dwordx4 v[44:47], v12, s[56:59], s14 offen
    ds_read_b128 v[72:75], v4 offset:384
    ds_read_b128 v[76:79], v4 offset:448
    s_waitcnt lgkmcnt(6)
    v_mfma_f32_16x16x32_bf16 v[28:31], a[4:7], v[52:55], v[28:31]
    ds_read_b128 v[48:51], v4 offset:22016
    ds_read2_b32 a[64:65], v7 offset0:128 offset1:129
    ds_read2_b32 a[66:67], v7 offset0:130 offset1:131
    s_waitcnt lgkmcnt(8)
    v_mfma_f32_16x16x32_bf16 v[28:31], a[8:11], v[56:59], v[28:31]
    ds_write_b16 v14, v3 offset:33824
    ds_write_b16 v14, v3 offset:35934
    ds_read2_b32 a[32:33], v7 offset0:0 offset1:1
    ds_read2_b32 a[34:35], v7 offset0:2 offset1:3
    s_waitcnt lgkmcnt(11)
    v_mfma_f32_16x16x32_bf16 v[28:31], a[12:15], v[60:63], v[28:31]
    v_cvt_pk_bf16_f32 v84, v24, v25
    v_cvt_pk_bf16_f32 v85, v26, v27
    ds_write_b16 v9, v84 offset:2304
    ds_write_b16_d16_hi v9, v84 offset:2308
    ds_write_b16 v9, v85 offset:2312
    s_waitcnt lgkmcnt(13)
    ds_write_b16_d16_hi v9, v85 offset:2316
    v_mfma_f32_16x16x32_bf16 v[28:31], a[16:19], v[64:67], v[28:31]
    s_waitcnt lgkmcnt(13)
    v_mfma_f32_16x16x32_bf16 v[28:31], a[20:23], v[68:71], v[28:31]
    ds_read_b128 v[52:55], v4 offset:22080
    s_waitcnt lgkmcnt(13)
    v_mfma_f32_16x16x32_bf16 v[28:31], a[24:27], v[72:75], v[28:31]
    ds_read_b128 v[56:59], v4 offset:22144
    s_waitcnt lgkmcnt(13)
    v_mfma_f32_16x16x32_bf16 v[28:31], a[28:31], v[76:79], v[28:31]
    s_nop 7
    v_cvt_pk_bf16_f32 v84, v28, v29
    v_cvt_pk_bf16_f32 v85, v30, v31
    ds_write_b16 v9, v84 offset:3456
    s_waitcnt lgkmcnt(13)
    ds_write_b16_d16_hi v9, v84 offset:3460
    s_waitcnt lgkmcnt(13)
    ds_write_b16 v9, v85 offset:3464
    s_waitcnt lgkmcnt(13)
    ds_write_b16_d16_hi v9, v85 offset:3468
    v_mfma_f32_16x16x32_bf16 v[28:31], a[128:131], v[48:51], 0
    v_mfma_f32_16x16x32_bf16 v[24:27], a[96:99], v[48:51], 0
    v_mfma_f32_16x16x32_bf16 v[20:23], a[64:67], v[48:51], 0
    s_waitcnt lgkmcnt(10)
    v_mfma_f32_16x16x32_bf16 v[16:19], a[32:35], v[48:51], 0
    ds_read2_b32 a[132:133], v8 offset0:144 offset1:145
    ds_read2_b32 a[134:135], v8 offset0:146 offset1:147
    ds_read2_b32 a[100:101], v8 offset0:16 offset1:17
    ds_read2_b32 a[102:103], v8 offset0:18 offset1:19
    s_waitcnt lgkmcnt(2)
    v_mfma_f32_16x16x32_bf16 v[28:31], a[132:135], v[52:55], v[28:31]
    ds_read2_b32 a[68:69], v7 offset0:144 offset1:145
    ds_read2_b32 a[70:71], v7 offset0:146 offset1:147
    ds_read2_b32 a[36:37], v7 offset0:16 offset1:17
    ds_read2_b32 a[38:39], v7 offset0:18 offset1:19
    s_waitcnt lgkmcnt(4)
    v_mfma_f32_16x16x32_bf16 v[24:27], a[100:103], v[52:55], v[24:27]
    ds_read2_b32 a[136:137], v8 offset0:160 offset1:161
    ds_read2_b32 a[138:139], v8 offset0:162 offset1:163
    ds_read2_b32 a[104:105], v8 offset0:32 offset1:33
    ds_read2_b32 a[106:107], v8 offset0:34 offset1:35
    s_waitcnt lgkmcnt(6)
    v_mfma_f32_16x16x32_bf16 v[20:23], a[68:71], v[52:55], v[20:23]
    ds_read2_b32 a[72:73], v7 offset0:160 offset1:161
    ds_read2_b32 a[74:75], v7 offset0:162 offset1:163
    ds_read2_b32 a[40:41], v7 offset0:32 offset1:33
    ds_read2_b32 a[42:43], v7 offset0:34 offset1:35
    s_waitcnt lgkmcnt(8)
    v_mfma_f32_16x16x32_bf16 v[16:19], a[36:39], v[52:55], v[16:19]
    ds_read_b128 v[60:63], v4 offset:22208
    ds_read2_b32 a[140:141], v8 offset0:176 offset1:177
    ds_read2_b32 a[142:143], v8 offset0:178 offset1:179
    ds_read2_b32 a[108:109], v8 offset0:48 offset1:49
    ds_read2_b32 a[110:111], v8 offset0:50 offset1:51
    s_waitcnt lgkmcnt(11)
    v_mfma_f32_16x16x32_bf16 v[28:31], a[136:139], v[56:59], v[28:31]
    ds_read2_b32 a[76:77], v7 offset0:176 offset1:177
    ds_read2_b32 a[78:79], v7 offset0:178 offset1:179
    ds_read_b128 v[64:67], v4 offset:22272
    s_waitcnt lgkmcnt(12)
    v_mfma_f32_16x16x32_bf16 v[24:27], a[104:107], v[56:59], v[24:27]
    ds_read2_b32 a[44:45], v7 offset0:48 offset1:49
    ds_read2_b32 a[46:47], v7 offset0:50 offset1:51
    s_waitcnt lgkmcnt(12)
    v_mfma_f32_16x16x32_bf16 v[20:23], a[72:75], v[56:59], v[20:23]
    ds_read2_b32 a[144:145], v8 offset0:192 offset1:193
    ds_read2_b32 a[146:147], v8 offset0:194 offset1:195
    s_waitcnt lgkmcnt(12)
    v_mfma_f32_16x16x32_bf16 v[16:19], a[40:43], v[56:59], v[16:19]
    ds_read2_b32 a[112:113], v8 offset0:64 offset1:65
    ds_read2_b32 a[114:115], v8 offset0:66 offset1:67
    s_waitcnt lgkmcnt(11)
    v_mfma_f32_16x16x32_bf16 v[28:31], a[140:143], v[60:63], v[28:31]
    ds_read2_b32 a[80:81], v7 offset0:192 offset1:193
    ds_read2_b32 a[82:83], v7 offset0:194 offset1:195
    ds_read_b128 v[68:71], v4 offset:22336
    s_waitcnt lgkmcnt(12)
    v_mfma_f32_16x16x32_bf16 v[24:27], a[108:111], v[60:63], v[24:27]
    ds_read2_b32 a[48:49], v7 offset0:64 offset1:65
    ds_read2_b32 a[50:51], v7 offset0:66 offset1:67
    s_waitcnt lgkmcnt(12)
    v_mfma_f32_16x16x32_bf16 v[20:23], a[76:79], v[60:63], v[20:23]
    ds_read2_b32 a[148:149], v8 offset0:208 offset1:209
    ds_read2_b32 a[150:151], v8 offset0:210 offset1:211
    s_waitcnt lgkmcnt(11)
    v_mfma_f32_16x16x32_bf16 v[16:19], a[44:47], v[60:63], v[16:19]
    ds_read2_b32 a[116:117], v8 offset0:80 offset1:81
    ds_read2_b32 a[118:119], v8 offset0:82 offset1:83
    ds_read_b128 v[72:75], v4 offset:22400
    s_waitcnt lgkmcnt(12)
    v_mfma_f32_16x16x32_bf16 v[28:31], a[144:147], v[64:67], v[28:31]
    ds_read2_b32 a[84:85], v7 offset0:208 offset1:209
    ds_read2_b32 a[86:87], v7 offset0:210 offset1:211
    s_waitcnt lgkmcnt(12)
    v_mfma_f32_16x16x32_bf16 v[24:27], a[112:115], v[64:67], v[24:27]
    ds_read2_b32 a[52:53], v7 offset0:80 offset1:81
    ds_read2_b32 a[54:55], v7 offset0:82 offset1:83
    s_waitcnt lgkmcnt(12)
    v_mfma_f32_16x16x32_bf16 v[20:23], a[80:83], v[64:67], v[20:23]
    ds_read2_b32 a[152:153], v8 offset0:224 offset1:225
    ds_read2_b32 a[154:155], v8 offset0:226 offset1:227
    s_waitcnt lgkmcnt(11)
    v_mfma_f32_16x16x32_bf16 v[16:19], a[48:51], v[64:67], v[16:19]
    ds_read2_b32 a[120:121], v8 offset0:96 offset1:97
    ds_read2_b32 a[122:123], v8 offset0:98 offset1:99
    ds_read_b128 v[76:79], v4 offset:22464
    s_waitcnt lgkmcnt(12)
    v_mfma_f32_16x16x32_bf16 v[28:31], a[148:151], v[68:71], v[28:31]
    ds_read2_b32 a[88:89], v7 offset0:224 offset1:225
    ds_read2_b32 a[90:91], v7 offset0:226 offset1:227
    s_waitcnt lgkmcnt(12)
    v_mfma_f32_16x16x32_bf16 v[24:27], a[116:119], v[68:71], v[24:27]
    ds_read2_b32 a[56:57], v7 offset0:96 offset1:97
    ds_read2_b32 a[58:59], v7 offset0:98 offset1:99
    s_waitcnt lgkmcnt(11)
    v_mfma_f32_16x16x32_bf16 v[20:23], a[84:87], v[68:71], v[20:23]
    ds_read2_b32 a[156:157], v8 offset0:240 offset1:241
    ds_read2_b32 a[158:159], v8 offset0:242 offset1:243
    ds_read_b128 v[48:51], v4 offset:21504
    s_waitcnt lgkmcnt(12)
    v_mfma_f32_16x16x32_bf16 v[16:19], a[52:55], v[68:71], v[16:19]
    ds_read2_b32 a[124:125], v8 offset0:112 offset1:113
    ds_read2_b32 a[126:127], v8 offset0:114 offset1:115
    s_waitcnt lgkmcnt(12)
    v_mfma_f32_16x16x32_bf16 v[28:31], a[152:155], v[72:75], v[28:31]
    ds_read2_b32 a[92:93], v7 offset0:240 offset1:241
    ds_read2_b32 a[94:95], v7 offset0:242 offset1:243
    s_waitcnt lgkmcnt(12)
    v_mfma_f32_16x16x32_bf16 v[24:27], a[120:123], v[72:75], v[24:27]
    ds_read2_b32 a[60:61], v7 offset0:112 offset1:113
    ds_read2_b32 a[62:63], v7 offset0:114 offset1:115
    s_waitcnt lgkmcnt(11)
    v_mfma_f32_16x16x32_bf16 v[20:23], a[88:91], v[72:75], v[20:23]
    ds_read_b128 v[52:55], v4 offset:21568
    ds_read_b128 v[56:59], v4 offset:21632
    ds_read_b128 v[60:63], v4 offset:21696
    s_waitcnt lgkmcnt(12)
    v_mfma_f32_16x16x32_bf16 v[16:19], a[56:59], v[72:75], v[16:19]
    ds_read_b128 v[64:67], v4 offset:21760
    ds_read_b128 v[68:71], v4 offset:21824
    s_waitcnt lgkmcnt(12)
    v_mfma_f32_16x16x32_bf16 v[28:31], a[156:159], v[76:79], v[28:31]
    ds_read_b128 v[72:75], v4 offset:21888
    s_waitcnt lgkmcnt(10)
    v_mfma_f32_16x16x32_bf16 v[24:27], a[124:127], v[76:79], v[24:27]
    s_waitcnt lgkmcnt(8)
    v_mfma_f32_16x16x32_bf16 v[20:23], a[92:95], v[76:79], v[20:23]
    s_waitcnt lgkmcnt(6)
    v_mfma_f32_16x16x32_bf16 v[16:19], a[60:63], v[76:79], v[16:19]
    ds_read_b128 v[76:79], v4 offset:21952
    v_mfma_f32_16x16x32_bf16 v[28:31], a[96:99], v[48:51], v[28:31]
    v_mfma_f32_16x16x32_bf16 v[24:27], a[64:67], v[48:51], v[24:27]
    v_mfma_f32_16x16x32_bf16 v[20:23], a[32:35], v[48:51], v[20:23]
    s_waitcnt vmcnt(4)
    ds_read_b128 v[48:51], v4 offset:20992
    s_waitcnt lgkmcnt(7)
    v_mfma_f32_16x16x32_bf16 v[28:31], a[100:103], v[52:55], v[28:31]
    v_cvt_pk_bf16_f32 v84, v16, v17
    v_cvt_pk_bf16_f32 v85, v18, v19
    ds_write_b16 v9, v84 offset:2
    ds_write_b16_d16_hi v9, v84 offset:6
    ds_write_b16 v9, v85 offset:10
    ds_write_b16_d16_hi v9, v85 offset:14
    v_mfma_f32_16x16x32_bf16 v[24:27], a[68:71], v[52:55], v[24:27]
    v_mfma_f32_16x16x32_bf16 v[20:23], a[36:39], v[52:55], v[20:23]
    ds_read_b128 v[52:55], v4 offset:21056
    s_waitcnt lgkmcnt(11)
    v_mfma_f32_16x16x32_bf16 v[28:31], a[104:107], v[56:59], v[28:31]
    v_mfma_f32_16x16x32_bf16 v[24:27], a[72:75], v[56:59], v[24:27]
    v_mfma_f32_16x16x32_bf16 v[20:23], a[40:43], v[56:59], v[20:23]
    s_waitcnt lgkmcnt(1)
    s_barrier
    ds_read_b64_tr_b16 v[88:89], v10 offset:0
    ds_read_b64_tr_b16 v[90:91], v10 offset:18688
    ds_read_b128 v[56:59], v4 offset:21120
    v_mfma_f32_16x16x32_bf16 v[28:31], a[108:111], v[60:63], v[28:31]
    v_mfma_f32_16x16x32_bf16 v[24:27], a[76:79], v[60:63], v[24:27]
    v_mfma_f32_16x16x32_bf16 v[20:23], a[44:47], v[60:63], v[20:23]
    ds_read_b128 v[60:63], v4 offset:21184
    v_mfma_f32_16x16x32_bf16 v[28:31], a[112:115], v[64:67], v[28:31]
    s_waitcnt vmcnt(3)
    s_waitcnt lgkmcnt(2)
    v_and_or_b32 v92, v32, v86, s67
    v_and_or_b32 v93, v32, v87, s69
    v_mfma_f32_16x16x32_bf16 v[24:27], a[80:83], v[64:67], v[24:27]
    v_and_or_b32 v94, v33, v86, s67
    v_and_or_b32 v95, v33, v87, s69
    v_dot2_f32_bf16 v92, v88, v92, 0
    v_mfma_f32_16x16x32_bf16 v[20:23], a[48:51], v[64:67], v[20:23]
    ds_read_b128 v[64:67], v4 offset:21248
    v_dot2_f32_bf16 v93, v88, v93, 0
    v_dot2_f32_bf16 v94, v89, v94, 0
    v_dot2_f32_bf16 v95, v89, v95, 0
    v_mfma_f32_16x16x32_bf16 v[28:31], a[116:119], v[68:71], v[28:31]
    s_nop 1
    v_cvt_pk_bf16_f32 v88, v92, v93
    v_cvt_pk_bf16_f32 v89, v94, v95
    v_mfma_f32_16x16x32_bf16 v[24:27], a[84:87], v[68:71], v[24:27]
    v_and_or_b32 v92, v34, v86, s67
    v_and_or_b32 v93, v34, v87, s69
    v_and_or_b32 v94, v35, v86, s67
    v_mfma_f32_16x16x32_bf16 v[20:23], a[52:55], v[68:71], v[20:23]
    ds_read_b128 v[68:71], v4 offset:21312
    v_and_or_b32 v95, v35, v87, s69
    v_dot2_f32_bf16 v92, v90, v92, 0
    v_dot2_f32_bf16 v93, v90, v93, 0
    v_mfma_f32_16x16x32_bf16 v[28:31], a[120:123], v[72:75], v[28:31]
    v_dot2_f32_bf16 v94, v91, v94, 0
    v_dot2_f32_bf16 v95, v91, v95, 0
    s_nop 1
    v_mfma_f32_16x16x32_bf16 v[24:27], a[88:91], v[72:75], v[24:27]
    v_cvt_pk_bf16_f32 v90, v92, v93
    v_cvt_pk_bf16_f32 v91, v94, v95
    s_mov_b32 s68, 0
    buffer_store_dwordx4 v[88:91], v11, s[60:63], s68 offen
    v_mfma_f32_16x16x32_bf16 v[20:23], a[56:59], v[72:75], v[20:23]
    ds_read_b128 v[72:75], v4 offset:21376
    v_mfma_f32_16x16x32_bf16 v[28:31], a[124:127], v[76:79], v[28:31]
    v_mfma_f32_16x16x32_bf16 v[24:27], a[92:95], v[76:79], v[24:27]
    v_mfma_f32_16x16x32_bf16 v[20:23], a[60:63], v[76:79], v[20:23]
    ds_read_b128 v[76:79], v4 offset:21440
    v_mfma_f32_16x16x32_bf16 v[28:31], a[64:67], v[48:51], v[28:31]
    v_mfma_f32_16x16x32_bf16 v[24:27], a[32:35], v[48:51], v[24:27]
    ds_read_b128 v[48:51], v4 offset:20480
    v_mfma_f32_16x16x32_bf16 v[28:31], a[68:71], v[52:55], v[28:31]
    v_mfma_f32_16x16x32_bf16 v[24:27], a[36:39], v[52:55], v[24:27]
    s_nop 1
    v_cvt_pk_bf16_f32 v84, v20, v21
    v_cvt_pk_bf16_f32 v85, v22, v23
    ds_write_b16 v9, v84 offset:1154
    ds_write_b16_d16_hi v9, v84 offset:1158
    ds_write_b16 v9, v85 offset:1162
    ds_write_b16_d16_hi v9, v85 offset:1166
    ds_read_b128 v[52:55], v4 offset:20544
    s_waitcnt lgkmcnt(11)
    v_mfma_f32_16x16x32_bf16 v[28:31], a[72:75], v[56:59], v[28:31]
    v_mfma_f32_16x16x32_bf16 v[24:27], a[40:43], v[56:59], v[24:27]
    ds_read_b128 v[56:59], v4 offset:20608
    s_waitcnt lgkmcnt(11)
    v_mfma_f32_16x16x32_bf16 v[28:31], a[76:79], v[60:63], v[28:31]
    v_mfma_f32_16x16x32_bf16 v[24:27], a[44:47], v[60:63], v[24:27]
    ds_read_b128 v[60:63], v4 offset:20672
    s_waitcnt lgkmcnt(11)
    v_mfma_f32_16x16x32_bf16 v[28:31], a[80:83], v[64:67], v[28:31]
    s_waitcnt lgkmcnt(3)
    s_barrier
    ds_read_b64_tr_b16 v[88:89], v10 offset:1152
    ds_read_b64_tr_b16 v[90:91], v10 offset:19840
    v_mfma_f32_16x16x32_bf16 v[24:27], a[48:51], v[64:67], v[24:27]
    ds_read_b128 v[64:67], v4 offset:20736
    v_mfma_f32_16x16x32_bf16 v[28:31], a[84:87], v[68:71], v[28:31]
    v_mfma_f32_16x16x32_bf16 v[24:27], a[52:55], v[68:71], v[24:27]
    ds_read_b128 v[68:71], v4 offset:20800
    v_mfma_f32_16x16x32_bf16 v[28:31], a[88:91], v[72:75], v[28:31]
    s_waitcnt vmcnt(3)
    s_waitcnt lgkmcnt(2)
    v_and_or_b32 v92, v36, v86, s67
    v_and_or_b32 v93, v36, v87, s69
    v_mfma_f32_16x16x32_bf16 v[24:27], a[56:59], v[72:75], v[24:27]
    ds_read_b128 v[72:75], v4 offset:20864
    v_and_or_b32 v94, v37, v86, s67
    v_and_or_b32 v95, v37, v87, s69
    v_dot2_f32_bf16 v92, v88, v92, 0
    v_mfma_f32_16x16x32_bf16 v[28:31], a[92:95], v[76:79], v[28:31]
    v_dot2_f32_bf16 v93, v88, v93, 0
    v_dot2_f32_bf16 v94, v89, v94, 0
    v_dot2_f32_bf16 v95, v89, v95, 0
    v_mfma_f32_16x16x32_bf16 v[24:27], a[60:63], v[76:79], v[24:27]
    ds_read_b128 v[76:79], v4 offset:20928
    s_nop 1
    v_cvt_pk_bf16_f32 v88, v92, v93
    v_cvt_pk_bf16_f32 v89, v94, v95
    v_mfma_f32_16x16x32_bf16 v[28:31], a[32:35], v[48:51], v[28:31]
    v_and_or_b32 v92, v38, v86, s67
    v_and_or_b32 v93, v38, v87, s69
    v_and_or_b32 v94, v39, v86, s67
    v_mfma_f32_16x16x32_bf16 v[28:31], a[36:39], v[52:55], v[28:31]
    v_and_or_b32 v95, v39, v87, s69
    v_dot2_f32_bf16 v92, v90, v92, 0
    v_dot2_f32_bf16 v93, v90, v93, 0
    v_mfma_f32_16x16x32_bf16 v[28:31], a[40:43], v[56:59], v[28:31]
    v_dot2_f32_bf16 v94, v91, v94, 0
    v_dot2_f32_bf16 v95, v91, v95, 0
    s_nop 1
    v_mfma_f32_16x16x32_bf16 v[28:31], a[44:47], v[60:63], v[28:31]
    v_cvt_pk_bf16_f32 v84, v24, v25
    v_cvt_pk_bf16_f32 v85, v26, v27
    ds_write_b16 v9, v84 offset:2306
    ds_write_b16_d16_hi v9, v84 offset:2310
    ds_write_b16 v9, v85 offset:2314
    ds_write_b16_d16_hi v9, v85 offset:2318
    v_cvt_pk_bf16_f32 v90, v92, v93
    v_cvt_pk_bf16_f32 v91, v94, v95
    s_mov_b32 s68, 655360
    buffer_store_dwordx4 v[88:91], v11, s[60:63], s68 offen
    s_waitcnt lgkmcnt(7)
    v_mfma_f32_16x16x32_bf16 v[28:31], a[48:51], v[64:67], v[28:31]
    s_waitcnt lgkmcnt(6)
    v_mfma_f32_16x16x32_bf16 v[28:31], a[52:55], v[68:71], v[28:31]
    s_waitcnt lgkmcnt(5)
    v_mfma_f32_16x16x32_bf16 v[28:31], a[56:59], v[72:75], v[28:31]
    s_waitcnt lgkmcnt(4)
    v_mfma_f32_16x16x32_bf16 v[28:31], a[60:63], v[76:79], v[28:31]
    s_nop 7
    v_cvt_pk_bf16_f32 v84, v28, v29
    v_cvt_pk_bf16_f32 v85, v30, v31
    ds_write_b16 v9, v84 offset:3458
    ds_write_b16_d16_hi v9, v84 offset:3462
    ds_write_b16 v9, v85 offset:3466
    ds_write_b16_d16_hi v9, v85 offset:3470
    s_waitcnt lgkmcnt(4)
    s_barrier
    ds_read_b64_tr_b16 v[88:89], v10 offset:2304
    ds_read_b64_tr_b16 v[90:91], v10 offset:20992
    s_waitcnt vmcnt(3)
    s_waitcnt lgkmcnt(0)
    v_and_or_b32 v92, v40, v86, s67
    v_and_or_b32 v93, v40, v87, s69
    v_and_or_b32 v94, v41, v86, s67
    v_and_or_b32 v95, v41, v87, s69
    v_dot2_f32_bf16 v92, v88, v92, 0
    v_dot2_f32_bf16 v93, v88, v93, 0
    v_dot2_f32_bf16 v94, v89, v94, 0
    v_dot2_f32_bf16 v95, v89, v95, 0
    s_nop 1
    v_cvt_pk_bf16_f32 v88, v92, v93
    v_cvt_pk_bf16_f32 v89, v94, v95
    v_and_or_b32 v92, v42, v86, s67
    v_and_or_b32 v93, v42, v87, s69
    v_and_or_b32 v94, v43, v86, s67
    v_and_or_b32 v95, v43, v87, s69
    v_dot2_f32_bf16 v92, v90, v92, 0
    v_dot2_f32_bf16 v93, v90, v93, 0
    v_dot2_f32_bf16 v94, v91, v94, 0
    v_dot2_f32_bf16 v95, v91, v95, 0
    s_nop 1
    v_cvt_pk_bf16_f32 v90, v92, v93
    v_cvt_pk_bf16_f32 v91, v94, v95
    s_mov_b32 s68, 1310720
    buffer_store_dwordx4 v[88:91], v11, s[60:63], s68 offen
    s_barrier
    ds_read_b64_tr_b16 v[88:89], v10 offset:3456
    ds_read_b64_tr_b16 v[90:91], v10 offset:22144
    s_waitcnt vmcnt(3)
    s_waitcnt lgkmcnt(0)
    v_and_or_b32 v92, v44, v86, s67
    v_and_or_b32 v93, v44, v87, s69
    v_and_or_b32 v94, v45, v86, s67
    v_and_or_b32 v95, v45, v87, s69
    v_dot2_f32_bf16 v92, v88, v92, 0
    v_dot2_f32_bf16 v93, v88, v93, 0
    v_dot2_f32_bf16 v94, v89, v94, 0
    v_dot2_f32_bf16 v95, v89, v95, 0
    s_nop 1
    v_cvt_pk_bf16_f32 v88, v92, v93
    v_cvt_pk_bf16_f32 v89, v94, v95
    v_and_or_b32 v92, v46, v86, s67
    v_and_or_b32 v93, v46, v87, s69
    v_and_or_b32 v94, v47, v86, s67
    v_and_or_b32 v95, v47, v87, s69
    v_dot2_f32_bf16 v92, v90, v92, 0
    v_dot2_f32_bf16 v93, v90, v93, 0
    v_dot2_f32_bf16 v94, v91, v94, 0
    v_dot2_f32_bf16 v95, v91, v95, 0
    s_nop 1
    v_cvt_pk_bf16_f32 v90, v92, v93
    v_cvt_pk_bf16_f32 v91, v94, v95
    s_mov_b32 s68, 1966080
    buffer_store_dwordx4 v[88:91], v11, s[60:63], s68 offen
L_end_T2:
    s_endpgm
L_conv_exit:
    s_endpgm
.section .rodata,"a"
.p2align 6
.amdhsa_kernel prep_kernel
  .amdhsa_next_free_vgpr 128
  .amdhsa_next_free_sgpr 80
  .amdhsa_accum_offset 128
  .amdhsa_group_segment_fixed_size 0
  .amdhsa_kernarg_size 128
  .amdhsa_user_sgpr_count 2
  .amdhsa_user_sgpr_kernarg_segment_ptr 1
  .amdhsa_system_sgpr_workgroup_id_x 1
.end_amdhsa_kernel

.p2align 6
.amdhsa_kernel conv_kernel
  .amdhsa_next_free_vgpr 256
  .amdhsa_next_free_sgpr 84
  .amdhsa_accum_offset 96
  .amdhsa_group_segment_fixed_size 0
  .amdhsa_kernarg_size 128
  .amdhsa_user_sgpr_count 2
  .amdhsa_user_sgpr_kernarg_segment_ptr 1
  .amdhsa_system_sgpr_workgroup_id_x 1
.end_amdhsa_kernel
```
